```python
import torch

def _softmax(x, axis=-1):
    return torch.softmax(x, dim=axis)
def _gelu(x):
    return torch.nn.functional.gelu(x, approximate="tanh")
def _silu(x):
    return torch.nn.functional.silu(x)
def _sigmoid(x):
    return torch.sigmoid(x)
def _layernorm(x, axis=-1, eps=1e-5):
    m = x.mean(dim=axis, keepdim=True)
    v = x.var(dim=axis, keepdim=True, unbiased=False)
    return (x - m) / torch.sqrt(v + eps)
def _scatter_add(tgt, idx, src, axis=0):
    return tgt.clone().index_add_(axis, idx, src)
def _segment_sum(src, seg, n):
    out = torch.zeros((n,) + src.shape[1:], dtype=src.dtype)
    return out.index_add_(0, seg, src)
def _pad(x, pw):
    flat = tuple(v for pair in reversed(pw) for v in pair)
    return torch.nn.functional.pad(x, flat)

kernel_name = 'parallel_sum__sliding_block__dense_activation_squared_relu__prompt'

def setup_inputs():

    _w = (lambda a: (lambda t: t.to(torch.bfloat16) if t.is_floating_point() else t)(torch.as_tensor(a)))
    def _A_setup():
        B, S, D = 1, 2048, 448
        return {
            "x": _w((lambda *s: torch.randn(*s, dtype=torch.bfloat16) * 0.05)(B, S, D)),
            "wqkv": _w((lambda *s: torch.randn(*s, dtype=torch.bfloat16) * 0.1)(D, 3 * D)),
            "wo": _w((lambda *s: torch.randn(*s, dtype=torch.bfloat16) * 0.05)(D, D)),
        }
    _A_in = _A_setup()

    def _B_setup():
        B, S, D, F = 1, 2048, 448, 1792
        return {
            "x": _w((lambda *s: torch.randn(*s, dtype=torch.bfloat16) * 0.05)(B, S, D)),
            "w1": _w((lambda *s: torch.randn(*s, dtype=torch.bfloat16) * 0.05)(D, F)),
            "b1": _w((lambda *s: torch.randn(*s, dtype=torch.bfloat16) * 0.4)(F)),
            "w2": _w((lambda *s: torch.randn(*s, dtype=torch.bfloat16) * 0.05)(F, D)),
            "b2": _w((lambda *s: torch.randn(*s, dtype=torch.bfloat16) * 1.6)(D)),
        }
    _B_in = _B_setup()

    return {
        "A_x": _A_in["x"],
        "A_wqkv": _A_in["wqkv"],
        "A_wo": _A_in["wo"],
        "B_x": _B_in["x"],
        "B_w1": _B_in["w1"],
        "B_b1": _B_in["b1"],
        "B_w2": _B_in["w2"],
        "B_b2": _B_in["b2"],
    }

def reference(A_x, A_wqkv, A_wo, B_x, B_w1, B_b1, B_w2, B_b2):
    def _A_ref(x, wqkv, wo):
        B, S, D = x.shape
        H = 16; Dh = D // H; W = 256
        qkv = (lambda x, *d: x.permute(*d))((x @ wqkv).reshape(B, S, 3, H, Dh), 2, 0, 3, 1, 4)
        q, k, v = qkv[0], qkv[1], qkv[2]
        scores = torch.einsum("bhqd,bhkd->bhqk", q, k) * (Dh ** -0.5)
        idx = torch.arange(S)
        mask = (idx[:, None] - idx[None, :] >= 0) & (idx[:, None] - idx[None, :] < W)
        scores = torch.where(mask[None, None], scores, -1e9)
        p = _softmax(scores, axis=-1)
        o = torch.einsum("bhqk,bhkd->bhqd", p, v)
        return (lambda x, *d: x.permute(*d))(o, 0, 2, 1, 3).reshape(B, S, D) @ wo

    def _B_ref(x, w1, b1, w2, b2):
        h = torch.einsum("bsd,df->bsf", x, w1) + b1
        zero = torch.zeros_like(h)
        r = torch.where(h > zero, h, zero)
        h = r * r
        out = torch.einsum("bsf,fd->bsd", h, w2) + b2
        return out

    x = A_x
    xn = _layernorm(x, axis=-1)
    return x + _A_ref(xn, A_wqkv, A_wo) + _B_ref(xn, B_w1, B_b1, B_w2, B_b2)
```

```asm
; @launch grid=(256,1,1) block=(512,1,1) lds=163840
.amdgcn_target "amdgcn-amd-amdhsa--gfx950"
.text
.p2align 8
.globl parallel_sum__sliding_block__dense_activation_squared_relu__prompt_kernel
.type parallel_sum__sliding_block__dense_activation_squared_relu__prompt_kernel,@function
parallel_sum__sliding_block__dense_activation_squared_relu__prompt_kernel:
    s_getpc_b64 s[50:51]
    s_load_dwordx2 s[4:5], s[0:1], 0
    s_load_dwordx2 s[8:9], s[0:1], 32
    s_load_dwordx2 s[12:13], s[0:1], 8
    s_cmp_ge_u32 s2, 256
    s_cbranch_scc1 K_end
    s_lshr_b32 s42, s2, 3
    s_and_b32 s48, s42, 3
    v_cmp_gt_u32 vcc, 128, v0
    v_lshl_add_u32 v228, v0, 2, s48
    v_lshlrev_b32 v228, 7, v228
    v_min_u32 v228, K_end-parallel_sum__sliding_block__dense_activation_squared_relu__prompt_kernel-8, v228
    s_cbranch_vccz NOPF
    global_load_dword v230, v228, s[50:51]
NOPF:
    v_lshrrev_b32 v241, 6, v0
    v_and_b32 v240, 63, v0
    v_readfirstlane_b32 s3, v241
    s_and_b32 s41, s2, 7
    s_and_b32 s43, s41, 3
    s_lshl_b32 s43, s43, 2
    s_add_u32 s43, s43, s48
    s_and_b32 s40, s3, 3
    s_lshl_b32 s43, s43, 2
    s_add_u32 s43, s43, s40
    s_lshr_b32 s45, s42, 2
    s_lshr_b32 s44, s41, 2
    s_lshl_b32 s44, s44, 3
    s_add_u32 s44, s44, s45
    s_add_u32 s44, s44, 1
    s_and_b32 s44, s44, 15
    s_cmp_lt_u32 s3, 3
    s_cbranch_scc1 G_prog
    s_cmp_eq_u32 s3, 3
    s_cbranch_scc0 L_go
    s_cmp_ge_u32 s2, 8
    s_cbranch_scc1 G_prog
    s_load_dwordx2 s[36:37], s[0:1], 72
    s_memrealtime s[60:61]
    s_movk_i32 s38, 256
    s_mov_b32 s39, 0x20000
    v_mov_b32 v50, 0
    v_mov_b32 v51, 0
    s_waitcnt lgkmcnt(0)
    s_or_b32 s60, s60, 1
    v_mov_b32 v48, s60
    v_mov_b32 v49, s61
    s_mov_b64 exec, 1
    buffer_atomic_cmpswap_x2 v[48:51], v50, s[36:39], 0 offen sc1
    s_mov_b64 exec, -1
    s_branch G_prog
L_go:
    s_lshl_b32 s47, s48, 1
    s_add_u32 s47, s47, s45
    s_sub_u32 s48, s47, 7
    s_cmp_ge_u32 s47, 7
    s_cselect_b32 s47, s48, s47
    v_lshrrev_b32 v241, 3, v240
    v_and_b32 v247, 7, v240
    v_lshrrev_b32 v248, 1, v241
    v_xor_b32 v248, v247, v248
    v_mul_u32_u24 v60, 896, v241
    v_lshl_add_u32 v60, v248, 4, v60
    v_xor_b32 v61, 64, v60
    v_add_u32 v61, 6144, v61
    v_add_u32 v62, 12288, v60
    v_add_u32 v63, 12288, v61
    s_mul_i32 s43, s43, 28672
    s_lshl_b32 s101, s47, 7
    s_add_u32 s101, s101, s43
    s_lshl_b32 s55, s40, 12
    s_mov_b32 s6, 1835008
    s_mov_b32 s7, 0x20000
    s_add_u32 s100, s43, 896
    s_add_u32 m0, s55, 0
    s_waitcnt lgkmcnt(0)
    buffer_load_dwordx4 v60, s[4:7], s101 offen offset:0 lds
    buffer_load_dwordx4 v61, s[4:7], s101 offen offset:1024 lds
    buffer_load_dwordx4 v62, s[4:7], s101 offen offset:2048 lds
    buffer_load_dwordx4 v63, s[4:7], s101 offen offset:3072 lds
    s_add_u32 s101, s101, 128
    s_cmp_eq_u32 s101, s100
    s_cselect_b32 s101, s43, s101
    v_and_b32 v242, 16, v240
    v_lshrrev_b32 v242, 2, v242
    v_xor_b32 v242, v242, v247
    v_lshlrev_b32 v242, 4, v242
    s_lshl_b32 s49, s40, 3
    v_add_u32 v243, s49, v241
    s_lshl_b32 s49, s44, 7
    v_add_u32 v246, s49, v242
    s_movk_i32 s50, 2688
    s_movk_i32 s51, 3584
    v_mad_u32_u24 v244, v243, s50, v246
    v_mad_u32_u24 v245, v243, s51, v246
    s_lshl_b32 s50, s40, 10
    s_mul_i32 s51, s47, 172032
    s_mov_b32 s14, 1204224
    s_mov_b32 s15, s7
    s_mov_b32 s10, 1605632
    s_mov_b32 s11, s7
    s_add_u32 m0, s50, 16384
    s_nop 0
    buffer_load_dwordx4 v244, s[12:15], s51 offen lds
    s_add_u32 s51, s51, 86016
    s_add_u32 m0, s50, 20480
    s_nop 0
    buffer_load_dwordx4 v244, s[12:15], s51 offen lds
    s_add_u32 s51, s51, 86016
    s_cmp_eq_u32 s51, 1204224
    s_cselect_b32 s51, 0, s51
    s_cmp_lt_u32 s44, 5
    s_cselect_b32 s56, s12, s8
    s_cselect_b32 s57, s13, s9
    s_cselect_b32 s58, s14, s10
    s_mov_b32 s99, s58
    s_mov_b32 s59, s7
    s_mov_b32 s48, 114688
    s_cselect_b32 s48, 86016, s48
    s_cselect_b64 vcc, -1, 0
    v_add_u32 v246, 2048, v244
    v_subrev_u32 v247, 640, v245
    v_cndmask_b32 v246, v247, v246, vcc
    s_mul_i32 s52, s47, s48
    s_lshl_b32 s52, s52, 1
    s_add_u32 m0, s50, 24576
    s_nop 0
    buffer_load_dwordx4 v246, s[56:59], s52 offen lds
    s_add_u32 s52, s52, s48
    s_add_u32 m0, s50, 28672
    s_nop 0
    buffer_load_dwordx4 v246, s[56:59], s52 offen lds
    s_add_u32 s52, s52, s48
    s_cmp_eq_u32 s52, s99
    s_cselect_b32 s52, 0, s52
    s_setprio 1
    s_load_dwordx2 s[36:37], s[0:1], 72
    s_load_dwordx2 s[16:17], s[0:1], 80
    s_load_dwordx2 s[20:21], s[0:1], 40
    s_load_dwordx2 s[24:25], s[0:1], 48
    s_load_dwordx2 s[28:29], s[0:1], 16
    s_load_dwordx2 s[32:33], s[0:1], 64
    s_load_dwordx2 s[96:97], s[0:1], 56
    s_mov_b32 s38, 256
    s_mov_b32 s39, 0x20000
    s_mov_b32 s18, 15597568
    s_mov_b32 s19, 0x20000
    s_mov_b32 s22, 3584
    s_mov_b32 s23, 0x20000
    s_mov_b32 s26, 1605632
    s_mov_b32 s27, 0x20000
    s_mov_b32 s30, 401408
    s_mov_b32 s31, 0x20000
    s_mov_b32 s34, 1835008
    s_mov_b32 s35, 0x20000
    v_mov_b32 v255, 155648
    s_lshl_b32 s46, s40, 2
    s_add_u32 s46, s46, 155648
    s_waitcnt lgkmcnt(0)
    s_barrier
    s_add_u32 m0, s46, 0
    s_mov_b64 exec, 1
    buffer_load_dword v255, s[36:39], 0 offen lds
    s_mov_b64 exec, -1
    s_add_u32 m0, s55, 32768
    s_nop 0
    buffer_load_dwordx4 v60, s[4:7], s101 offen offset:0 lds
    buffer_load_dwordx4 v61, s[4:7], s101 offen offset:1024 lds
    buffer_load_dwordx4 v62, s[4:7], s101 offen offset:2048 lds
    buffer_load_dwordx4 v63, s[4:7], s101 offen offset:3072 lds
    s_add_u32 s101, s101, 128
    s_cmp_eq_u32 s101, s100
    s_cselect_b32 s101, s43, s101
    s_add_u32 m0, s50, 49152
    s_nop 0
    buffer_load_dwordx4 v244, s[12:15], s51 offen lds
    s_add_u32 s51, s51, 86016
    s_add_u32 m0, s50, 53248
    s_nop 0
    buffer_load_dwordx4 v244, s[12:15], s51 offen lds
    s_add_u32 s51, s51, 86016
    s_cmp_eq_u32 s51, 1204224
    s_cselect_b32 s51, 0, s51
    s_add_u32 m0, s50, 57344
    s_nop 0
    buffer_load_dwordx4 v246, s[56:59], s52 offen lds
    s_add_u32 s52, s52, s48
    s_add_u32 m0, s50, 61440
    s_nop 0
    buffer_load_dwordx4 v246, s[56:59], s52 offen lds
    s_add_u32 s52, s52, s48
    s_cmp_eq_u32 s52, s99
    s_cselect_b32 s52, 0, s52
    s_add_u32 m0, s46, 16
    s_mov_b64 exec, 1
    buffer_load_dword v255, s[36:39], 0 offen lds
    s_mov_b64 exec, -1
    v_add_u32 v247, 1408, v245
    v_add_u32 v248, 3456, v245
    v_subrev_u32 v248, s49, v248
    s_mul_i32 s53, s47, 229376
    s_mov_b32 s54, s53
    v_and_b32 v249, 51, v240
    v_bfe_u32 v250, v240, 2, 1
    v_lshl_add_u32 v249, v250, 3, v249
    v_bfe_u32 v250, v240, 3, 1
    v_lshl_add_u32 v249, v250, 2, v249
    v_lshlrev_b32 v249, 1, v249
    v_mov_b32 v224, 0
    v_bfe_u32 v250, v240, 4, 1
    v_lshlrev_b32 v250, 5, v250
    v_and_b32 v251, 1, v240
    v_lshl_add_u32 v250, v251, 4, v250
    v_bfe_u32 v251, v240, 1, 1
    v_lshl_add_u32 v250, v251, 3, v250
    v_bfe_u32 v251, v240, 2, 2
    v_lshl_add_u32 v250, v251, 7, v250
    v_lshrrev_b32 v251, 1, v251
    v_lshrrev_b32 v252, 5, v240
    v_xor_b32 v251, v251, v252
    v_lshl_add_u32 v250, v251, 6, v250
    v_add_u32 v250, s50, v250
    v_add_u32 v251, 81920, v250
    v_lshrrev_b32 v253, 5, v240
    v_lshlrev_b32 v253, 10, v253
    v_and_b32 v228, 31, v240
    v_lshl_add_u32 v253, v228, 4, v253
    s_lshr_b32 s62, s40, 1
    s_lshl_b32 s62, s62, 9
    s_and_b32 s63, s40, 1
    s_lshl_b32 s63, s63, 3
    s_add_u32 s62, s62, s63
    s_add_u32 s62, s62, 156672
    v_add_u32 v253, s62, v253
    v_mov_b32 v254, s46
    v_mov_b32 v59, 0x3f803f80
    v_mov_b32 v228, 0
    v_mov_b32 v229, 0
    v_mov_b32 v230, 0
    v_mov_b32 v231, 0
    v_mov_b32 v232, 0
    v_mov_b32 v233, 0
    v_mov_b32 v234, 0
    v_mov_b32 v235, 0
    s_lshl_b32 s62, s41, 1
    s_and_b32 s63, s42, 1
    s_add_u32 s62, s62, s63
    s_mul_i32 s62, s62, 7
    s_lshr_b32 s62, s62, 1
    v_and_b32 v64, 1, v240
    v_mul_u32_u24 v65, 3, v64
    v_add_u32 v65, s62, v65
    v_lshrrev_b32 v65, 3, v65
    v_bfe_u32 v66, v240, 1, 2
    s_lshr_b32 s62, s42, 1
    s_lshl_b32 s62, s62, 2
    s_mul_i32 s63, s40, 3
    s_add_u32 s63, s63, s62
    s_sub_u32 s63, s63, 8
    s_add_u32 s62, s62, s40
    v_add_u32 v67, s63, v66
    v_mov_b32 v68, s62
    v_cmp_eq_u32 vcc, 3, v66
    s_nop 1
    v_cndmask_b32 v67, v67, v68, vcc
    v_add_u32 v69, 7, v65
    v_cndmask_b32 v69, v69, v65, vcc
    v_cmp_gt_i32 vcc, 0, v67
    s_nop 1
    v_cndmask_b32 v67, v67, v68, vcc
    v_add_u32 v65, 14, v65
    v_cmp_lt_u32 vcc, 7, v240
    s_nop 1
    v_cndmask_b32 v69, v69, v65, vcc
    s_and_b32 s62, s41, 3
    s_lshl_b32 s62, s62, 3
    s_lshr_b32 s63, s41, 2
    s_add_u32 s62, s62, s63
    s_and_b32 s63, s42, 3
    s_lshl_b32 s63, s63, 1
    s_add_u32 s62, s62, s63
    s_lshl_b32 s62, s62, 1
    v_add_u32 v64, s62, v64
    v_cmp_lt_u32 vcc, 15, v240
    s_nop 1
    v_cndmask_b32 v67, v67, v64, vcc
    s_mul_i32 s62, s40, 11
    s_lshr_b32 s62, s62, 2
    s_add_u32 s62, s62, 21
    v_add_u32 v68, s62, v66
    v_min_u32 v68, 31, v68
    s_lshl_b32 s62, s40, 2
    v_add_u32 v66, s62, v66
    v_add_u32 v65, 32, v66
    v_cndmask_b32 v69, v69, v68, vcc
    v_cmp_lt_u32 vcc, 23, v240
    s_nop 1
    v_cndmask_b32 v69, v69, v65, vcc
    v_mov_b32 v65, 48
    v_cmp_lt_u32 vcc, 31, v240
    s_nop 1
    v_cndmask_b32 v69, v69, v65, vcc
    v_lshlrev_b32 v238, 13, v67
    v_lshl_add_u32 v238, v69, 7, v238
    v_add_u32 v238, 14942208, v238
    v_lshlrev_b32 v64, 11, v64
    v_lshl_add_u32 v64, v66, 7, v64
    v_add_u32 v64, 15466496, v64
    v_cmp_lt_u32 vcc, 39, v240
    s_nop 1
    v_cndmask_b32 v238, v238, v64, vcc
    s_waitcnt vmcnt(11)
    ds_read_b64_tr_b16 v[0:1], v250 offset:16384
    ds_read_b64_tr_b16 v[2:3], v250 offset:16896
    ds_read_b64_tr_b16 v[4:5], v250 offset:20480
    ds_read_b64_tr_b16 v[6:7], v250 offset:20992
    s_add_u32 m0, s55, 65536
    s_nop 0
    buffer_load_dwordx4 v60, s[4:7], s101 offen offset:0 lds
    s_waitcnt vmcnt(11)
    ds_read_b64_tr_b16 v[8:9], v250 offset:24576
    ds_read_b64_tr_b16 v[10:11], v250 offset:25088
    ds_read_b64_tr_b16 v[12:13], v250 offset:28672
    ds_read_b64_tr_b16 v[14:15], v250 offset:29184
    buffer_load_dwordx4 v61, s[4:7], s101 offen offset:1024 lds
    s_waitcnt lgkmcnt(7)
    v_dot2c_f32_bf16 v228, v59, v0
    v_dot2c_f32_bf16 v229, v59, v1
    s_waitcnt lgkmcnt(6)
    v_dot2c_f32_bf16 v228, v59, v2
    v_dot2c_f32_bf16 v229, v59, v3
    s_waitcnt lgkmcnt(5)
    v_dot2c_f32_bf16 v228, v59, v4
    v_dot2c_f32_bf16 v229, v59, v5
    s_waitcnt lgkmcnt(4)
    v_dot2c_f32_bf16 v228, v59, v6
    v_dot2c_f32_bf16 v229, v59, v7
    s_waitcnt vmcnt(11)
    buffer_load_dwordx4 v62, s[4:7], s101 offen offset:2048 lds
    s_waitcnt vmcnt(11)
    buffer_load_dwordx4 v63, s[4:7], s101 offen offset:3072 lds
    s_add_u32 s101, s101, 128
    s_cmp_eq_u32 s101, s100
    s_cselect_b32 s101, s43, s101
    s_waitcnt vmcnt(11)
    s_add_u32 m0, s50, 81920
    s_nop 0
    buffer_load_dwordx4 v244, s[12:15], s51 offen lds
    s_add_u32 s51, s51, 86016
    s_waitcnt lgkmcnt(3)
    v_dot2c_f32_bf16 v230, v59, v8
    v_dot2c_f32_bf16 v231, v59, v9
    s_waitcnt lgkmcnt(2)
    v_dot2c_f32_bf16 v230, v59, v10
    v_dot2c_f32_bf16 v231, v59, v11
    s_waitcnt lgkmcnt(1)
    v_dot2c_f32_bf16 v230, v59, v12
    v_dot2c_f32_bf16 v231, v59, v13
    s_waitcnt lgkmcnt(0)
    v_dot2c_f32_bf16 v230, v59, v14
    v_dot2c_f32_bf16 v231, v59, v15
    s_waitcnt vmcnt(11)
    s_add_u32 m0, s50, 86016
    s_nop 0
    buffer_load_dwordx4 v244, s[12:15], s51 offen lds
    s_add_u32 s51, s51, 86016
    s_cmp_eq_u32 s51, 1204224
    s_cselect_b32 s51, 0, s51
    s_waitcnt vmcnt(11)
    s_add_u32 m0, s50, 90112
    s_nop 0
    buffer_load_dwordx4 v246, s[56:59], s52 offen lds
    s_add_u32 s52, s52, s48
    s_waitcnt vmcnt(11)
    s_add_u32 m0, s50, 94208
    s_nop 0
    buffer_load_dwordx4 v246, s[56:59], s52 offen lds
    s_add_u32 s52, s52, s48
    s_cmp_eq_u32 s52, s99
    s_cselect_b32 s52, 0, s52
    s_add_u32 m0, s46, 32
    s_mov_b64 exec, 1
    buffer_load_dword v255, s[36:39], 0 offen lds
    s_mov_b64 exec, -1
    s_cmp_lg_u32 s40, 0
    s_cselect_b32 s62, 134217728, s49
    buffer_load_ushort v226, v249, s[20:23], s62 offen offset:1408
    s_cselect_b32 s63, 134217728, 0
    buffer_load_ushort v227, v249, s[20:23], s63 offen offset:3456
    s_sub_u32 s62, s62, 640
    s_cmp_lt_u32 s44, 5
    s_cselect_b32 s62, 134217728, s62
    buffer_load_ushort v225, v249, s[20:23], s62 offen
    s_mov_b32 exec_hi, 0xff03
    buffer_load_dwordx2 v[54:55], v238, s[16:19], 0 offen sc1
    s_mov_b64 exec, -1
    s_waitcnt vmcnt(11)
    ds_read_b64_tr_b16 v[16:17], v250 offset:49152
    ds_read_b64_tr_b16 v[18:19], v250 offset:49664
    ds_read_b64_tr_b16 v[20:21], v250 offset:53248
    ds_read_b64_tr_b16 v[22:23], v250 offset:53760
    ds_read_b64_tr_b16 v[24:25], v250 offset:57344
    ds_read_b64_tr_b16 v[26:27], v250 offset:57856
    ds_read_b64_tr_b16 v[28:29], v250 offset:61440
    ds_read_b64_tr_b16 v[30:31], v250 offset:61952
    s_add_u32 m0, s55, 98304
    s_nop 0
    buffer_load_dwordx4 v60, s[4:7], s101 offen offset:0 lds
    s_waitcnt lgkmcnt(7)
    v_dot2c_f32_bf16 v228, v59, v16
    v_dot2c_f32_bf16 v229, v59, v17
    s_waitcnt lgkmcnt(6)
    v_dot2c_f32_bf16 v228, v59, v18
    v_dot2c_f32_bf16 v229, v59, v19
    s_waitcnt lgkmcnt(5)
    v_dot2c_f32_bf16 v228, v59, v20
    v_dot2c_f32_bf16 v229, v59, v21
    s_waitcnt lgkmcnt(4)
    v_dot2c_f32_bf16 v228, v59, v22
    v_dot2c_f32_bf16 v229, v59, v23
    s_waitcnt vmcnt(11)
    buffer_load_dwordx4 v61, s[4:7], s101 offen offset:1024 lds
    s_waitcnt vmcnt(11)
    buffer_load_dwordx4 v62, s[4:7], s101 offen offset:2048 lds
    s_waitcnt vmcnt(11)
    buffer_load_dwordx4 v63, s[4:7], s101 offen offset:3072 lds
    s_add_u32 s101, s101, 128
    s_cmp_eq_u32 s101, s100
    s_cselect_b32 s101, s43, s101
    s_waitcnt lgkmcnt(3)
    v_dot2c_f32_bf16 v230, v59, v24
    v_dot2c_f32_bf16 v231, v59, v25
    s_waitcnt lgkmcnt(2)
    v_dot2c_f32_bf16 v230, v59, v26
    v_dot2c_f32_bf16 v231, v59, v27
    s_waitcnt lgkmcnt(1)
    v_dot2c_f32_bf16 v230, v59, v28
    v_dot2c_f32_bf16 v231, v59, v29
    s_waitcnt lgkmcnt(0)
    v_dot2c_f32_bf16 v230, v59, v30
    v_dot2c_f32_bf16 v231, v59, v31
    s_waitcnt vmcnt(11)
    ds_read_b64_tr_b16 v[0:1], v251 offset:0
    ds_read_b64_tr_b16 v[2:3], v251 offset:512
    ds_read_b64_tr_b16 v[4:5], v251 offset:4096
    ds_read_b64_tr_b16 v[6:7], v251 offset:4608
    s_add_u32 m0, s50, 114688
    s_nop 0
    buffer_load_dwordx4 v244, s[12:15], s51 offen lds
    s_add_u32 s51, s51, 86016
    s_waitcnt vmcnt(11)
    s_add_u32 m0, s50, 118784
    s_nop 0
    buffer_load_dwordx4 v244, s[12:15], s51 offen lds
    s_add_u32 s51, s51, 86016
    s_cmp_eq_u32 s51, 1204224
    s_cselect_b32 s51, 0, s51
    s_waitcnt vmcnt(11)
    ds_read_b64_tr_b16 v[8:9], v251 offset:8192
    ds_read_b64_tr_b16 v[10:11], v251 offset:8704
    ds_read_b64_tr_b16 v[12:13], v251 offset:12288
    ds_read_b64_tr_b16 v[14:15], v251 offset:12800
    s_add_u32 m0, s50, 122880
    s_nop 0
    buffer_load_dwordx4 v246, s[56:59], s52 offen lds
    s_add_u32 s52, s52, s48
    s_waitcnt lgkmcnt(7)
    v_dot2c_f32_bf16 v228, v59, v0
    v_dot2c_f32_bf16 v229, v59, v1
    s_waitcnt lgkmcnt(6)
    v_dot2c_f32_bf16 v228, v59, v2
    v_dot2c_f32_bf16 v229, v59, v3
    s_waitcnt lgkmcnt(5)
    v_dot2c_f32_bf16 v228, v59, v4
    v_dot2c_f32_bf16 v229, v59, v5
    s_waitcnt lgkmcnt(4)
    v_dot2c_f32_bf16 v228, v59, v6
    v_dot2c_f32_bf16 v229, v59, v7
    s_waitcnt vmcnt(11)
    s_add_u32 m0, s50, 126976
    s_nop 0
    buffer_load_dwordx4 v246, s[56:59], s52 offen lds
    s_add_u32 s52, s52, s48
    s_cmp_eq_u32 s52, s99
    s_cselect_b32 s52, 0, s52
    s_add_u32 m0, s46, 48
    s_mov_b64 exec, 1
    buffer_load_dword v255, s[36:39], 0 offen lds
    s_mov_b64 exec, -1
    ds_read_b128 v[76:79], v255 offset:448
    s_waitcnt vmcnt(11)
    s_add_u32 m0, s55, 131072
    s_nop 0
    buffer_load_dwordx4 v60, s[4:7], s101 offen offset:0 lds
    s_waitcnt vmcnt(11)
    buffer_load_dwordx4 v61, s[4:7], s101 offen offset:1024 lds
    s_waitcnt lgkmcnt(4)
    v_dot2c_f32_bf16 v230, v59, v8
    v_dot2c_f32_bf16 v231, v59, v9
    s_waitcnt lgkmcnt(3)
    v_dot2c_f32_bf16 v230, v59, v10
    v_dot2c_f32_bf16 v231, v59, v11
    s_waitcnt lgkmcnt(2)
    v_dot2c_f32_bf16 v230, v59, v12
    v_dot2c_f32_bf16 v231, v59, v13
    s_waitcnt lgkmcnt(1)
    v_dot2c_f32_bf16 v230, v59, v14
    v_dot2c_f32_bf16 v231, v59, v15
    s_waitcnt vmcnt(11)
    buffer_load_dwordx4 v62, s[4:7], s101 offen offset:2048 lds
    s_waitcnt vmcnt(11)
    buffer_load_dwordx4 v63, s[4:7], s101 offen offset:3072 lds
    s_add_u32 s101, s101, 128
    s_cmp_eq_u32 s101, s100
    s_cselect_b32 s101, s43, s101
    s_waitcnt lgkmcnt(0)
    ds_read_b128 v[76:79], v255 offset:448
    s_waitcnt lgkmcnt(0)
    v_or3_b32 v76, v76, v77, v78
    v_or_b32 v76, v76, v79
    v_cmp_ne_u32 vcc, 0, v76
    s_nop 4
    s_cbranch_vccnz SLOW_1
RET_2:
    s_waitcnt vmcnt(11)
    s_add_u32 m0, s50, 0
    s_nop 0
    buffer_load_dwordx4 v244, s[12:15], s51 offen lds
    s_add_u32 s51, s51, 86016
    s_waitcnt vmcnt(11)
    s_add_u32 m0, s50, 4096
    s_nop 0
    buffer_load_dwordx4 v244, s[12:15], s51 offen lds
    s_add_u32 s51, s51, 86016
    s_cmp_eq_u32 s51, 1204224
    s_cselect_b32 s51, 0, s51
    ds_read_b128 v[76:79], v255 offset:464
    s_waitcnt vmcnt(11)
    s_add_u32 m0, s50, 8192
    s_nop 0
    buffer_load_dwordx4 v246, s[56:59], s52 offen lds
    s_add_u32 s52, s52, s48
    s_waitcnt vmcnt(11)
    s_add_u32 m0, s50, 12288
    s_nop 0
    buffer_load_dwordx4 v246, s[56:59], s52 offen lds
    s_add_u32 s52, s52, s48
    s_cmp_eq_u32 s52, s99
    s_cselect_b32 s52, 0, s52
    s_add_u32 m0, s46, 64
    s_mov_b64 exec, 1
    buffer_load_dword v255, s[36:39], 0 offen lds
    s_mov_b64 exec, -1
    s_waitcnt lgkmcnt(0)
    ds_read_b128 v[76:79], v255 offset:464
    s_waitcnt lgkmcnt(0)
    v_or3_b32 v76, v76, v77, v78
    v_or_b32 v76, v76, v79
    v_cmp_ne_u32 vcc, 0, v76
    s_nop 4
    s_cbranch_vccnz SLOW_3
RET_4:
    s_waitcnt vmcnt(11)
    ds_read_b64_tr_b16 v[16:17], v251 offset:32768
    ds_read_b64_tr_b16 v[18:19], v251 offset:33280
    ds_read_b64_tr_b16 v[20:21], v251 offset:36864
    ds_read_b64_tr_b16 v[22:23], v251 offset:37376
    s_add_u32 m0, s55, 32768
    s_nop 0
    buffer_load_dwordx4 v60, s[4:7], s101 offen offset:0 lds
    s_waitcnt vmcnt(11)
    ds_read_b64_tr_b16 v[24:25], v251 offset:40960
    ds_read_b64_tr_b16 v[26:27], v251 offset:41472
    ds_read_b64_tr_b16 v[28:29], v251 offset:45056
    ds_read_b64_tr_b16 v[30:31], v251 offset:45568
    buffer_load_dwordx4 v61, s[4:7], s101 offen offset:1024 lds
    s_waitcnt lgkmcnt(7)
    v_dot2c_f32_bf16 v228, v59, v16
    v_dot2c_f32_bf16 v229, v59, v17
    s_waitcnt lgkmcnt(6)
    v_dot2c_f32_bf16 v228, v59, v18
    v_dot2c_f32_bf16 v229, v59, v19
    s_waitcnt lgkmcnt(5)
    v_dot2c_f32_bf16 v228, v59, v20
    v_dot2c_f32_bf16 v229, v59, v21
    s_waitcnt lgkmcnt(4)
    v_dot2c_f32_bf16 v228, v59, v22
    v_dot2c_f32_bf16 v229, v59, v23
    s_waitcnt vmcnt(11)
    buffer_load_dwordx4 v62, s[4:7], s101 offen offset:2048 lds
    s_waitcnt vmcnt(11)
    buffer_load_dwordx4 v63, s[4:7], s101 offen offset:3072 lds
    s_add_u32 s101, s101, 128
    s_cmp_eq_u32 s101, s100
    s_cselect_b32 s101, s43, s101
    s_waitcnt vmcnt(11)
    s_add_u32 m0, s50, 16384
    s_nop 0
    buffer_load_dwordx4 v244, s[12:15], s51 offen lds
    s_add_u32 s51, s51, 86016
    s_waitcnt lgkmcnt(3)
    v_dot2c_f32_bf16 v230, v59, v24
    v_dot2c_f32_bf16 v231, v59, v25
    s_waitcnt lgkmcnt(2)
    v_dot2c_f32_bf16 v230, v59, v26
    v_dot2c_f32_bf16 v231, v59, v27
    s_waitcnt lgkmcnt(1)
    v_dot2c_f32_bf16 v230, v59, v28
    v_dot2c_f32_bf16 v231, v59, v29
    s_waitcnt lgkmcnt(0)
    v_dot2c_f32_bf16 v230, v59, v30
    v_dot2c_f32_bf16 v231, v59, v31
    s_waitcnt vmcnt(11)
    s_add_u32 m0, s50, 20480
    s_nop 0
    buffer_load_dwordx4 v244, s[12:15], s51 offen lds
    s_add_u32 s51, s51, 86016
    s_cmp_eq_u32 s51, 1204224
    s_cselect_b32 s51, 0, s51
    ds_read_b128 v[76:79], v255 offset:480
    s_waitcnt vmcnt(11)
    s_add_u32 m0, s50, 24576
    s_nop 0
    buffer_load_dwordx4 v246, s[56:59], s52 offen lds
    s_add_u32 s52, s52, s48
    s_waitcnt vmcnt(11)
    s_add_u32 m0, s50, 28672
    s_nop 0
    buffer_load_dwordx4 v246, s[56:59], s52 offen lds
    s_add_u32 s52, s52, s48
    s_cmp_eq_u32 s52, s99
    s_cselect_b32 s52, 0, s52
    s_add_u32 m0, s46, 80
    s_mov_b64 exec, 1
    buffer_load_dword v255, s[36:39], 0 offen lds
    s_mov_b64 exec, -1
    s_waitcnt lgkmcnt(0)
    ds_read_b128 v[76:79], v255 offset:480
    s_waitcnt lgkmcnt(0)
    v_or3_b32 v76, v76, v77, v78
    v_or_b32 v76, v76, v79
    v_cmp_ne_u32 vcc, 0, v76
    s_nop 4
    s_cbranch_vccnz SLOW_5
RET_6:
    s_waitcnt vmcnt(11)
    ds_read_b64_tr_b16 v[0:1], v250 offset:0
    ds_read_b64_tr_b16 v[2:3], v250 offset:512
    ds_read_b64_tr_b16 v[4:5], v250 offset:4096
    ds_read_b64_tr_b16 v[6:7], v250 offset:4608
    s_add_u32 m0, s55, 65536
    s_nop 0
    buffer_load_dwordx4 v60, s[4:7], s101 offen offset:0 lds
    s_waitcnt vmcnt(11)
    ds_read_b64_tr_b16 v[8:9], v250 offset:8192
    ds_read_b64_tr_b16 v[10:11], v250 offset:8704
    ds_read_b64_tr_b16 v[12:13], v250 offset:12288
    ds_read_b64_tr_b16 v[14:15], v250 offset:12800
    buffer_load_dwordx4 v61, s[4:7], s101 offen offset:1024 lds
    s_waitcnt lgkmcnt(7)
    v_dot2c_f32_bf16 v228, v59, v0
    v_dot2c_f32_bf16 v229, v59, v1
    s_waitcnt lgkmcnt(6)
    v_dot2c_f32_bf16 v228, v59, v2
    v_dot2c_f32_bf16 v229, v59, v3
    s_waitcnt lgkmcnt(5)
    v_dot2c_f32_bf16 v228, v59, v4
    v_dot2c_f32_bf16 v229, v59, v5
    s_waitcnt lgkmcnt(4)
    v_dot2c_f32_bf16 v228, v59, v6
    v_dot2c_f32_bf16 v229, v59, v7
    s_waitcnt vmcnt(11)
    buffer_load_dwordx4 v62, s[4:7], s101 offen offset:2048 lds
    s_waitcnt vmcnt(11)
    buffer_load_dwordx4 v63, s[4:7], s101 offen offset:3072 lds
    s_add_u32 s101, s101, 128
    s_cmp_eq_u32 s101, s100
    s_cselect_b32 s101, s43, s101
    s_waitcnt vmcnt(11)
    s_add_u32 m0, s50, 49152
    s_nop 0
    buffer_load_dwordx4 v244, s[12:15], s51 offen lds
    s_add_u32 s51, s51, 86016
    s_waitcnt lgkmcnt(3)
    v_dot2c_f32_bf16 v230, v59, v8
    v_dot2c_f32_bf16 v231, v59, v9
    s_waitcnt lgkmcnt(2)
    v_dot2c_f32_bf16 v230, v59, v10
    v_dot2c_f32_bf16 v231, v59, v11
    s_waitcnt lgkmcnt(1)
    v_dot2c_f32_bf16 v230, v59, v12
    v_dot2c_f32_bf16 v231, v59, v13
    s_waitcnt lgkmcnt(0)
    v_dot2c_f32_bf16 v230, v59, v14
    v_dot2c_f32_bf16 v231, v59, v15
    s_waitcnt vmcnt(11)
    s_add_u32 m0, s50, 53248
    s_nop 0
    buffer_load_dwordx4 v244, s[12:15], s51 offen lds
    s_add_u32 s51, s51, 86016
    s_cmp_eq_u32 s51, 1204224
    s_cselect_b32 s51, 0, s51
    s_waitcnt vmcnt(11)
    s_add_u32 m0, s50, 57344
    s_nop 0
    buffer_load_dwordx4 v246, s[56:59], s52 offen lds
    s_add_u32 s52, s52, s48
    s_waitcnt vmcnt(11)
    s_add_u32 m0, s50, 61440
    s_nop 0
    buffer_load_dwordx4 v246, s[56:59], s52 offen lds
    s_add_u32 s52, s52, s48
    s_cmp_eq_u32 s52, s99
    s_cselect_b32 s52, 0, s52
    s_add_u32 m0, s46, 96
    s_mov_b64 exec, 1
    buffer_load_dword v255, s[36:39], 0 offen lds
    s_mov_b64 exec, -1
    ds_read_b128 v[76:79], v255 offset:496
    s_and_b32 s62, s42, 3
    s_min_u32 s47, s45, 6
    s_mul_i32 s20, s47, 3
    s_lshr_b32 s20, s20, 1
    s_mul_i32 s21, s62, 3
    s_add_u32 s20, s20, s21
    s_sub_u32 s21, s20, 11
    s_cmp_ge_u32 s20, 11
    s_cselect_b32 s20, s21, s20
    s_lshl_b32 s21, s47, 1
    s_lshl_b32 s22, s62, 2
    s_add_u32 s21, s21, s22
    s_and_b32 s21, s21, 15
    s_add_u32 s22, s62, s47
    s_and_b32 s22, s22, 3
    s_lshl_b32 s23, s21, 8
    s_or_b32 s23, s23, s20
    s_lshl_b32 s62, s22, 16
    s_or_b32 s23, s23, s62
    s_mul_i32 s20, s20, 14336
    s_mul_i32 s21, s21, 14336
    s_mul_i32 s22, s22, 25088
    s_lshl_b32 s47, s47, 7
    v_mul_u32_u24 v236, 896, v241
    v_add_u32 v236, v236, v242
    v_add_u32 v236, s47, v236
    s_cmp_eq_u32 s45, 7
    s_cselect_b32 s62, 134217728, 0
    v_add_u32 v236, s62, v236
    s_mul_i32 s62, s40, 157696
    v_add_u32 v220, s62, v236
    s_mul_i32 s62, s40, 229376
    s_add_u32 s62, s62, 630784
    v_add_u32 v221, s62, v236
    s_mul_i32 s62, s40, 14336
    s_add_u32 s62, s62, 1548288
    v_add_u32 v222, s62, v236
    s_mul_i32 s62, s40, 100352
    v_add_u32 v223, s62, v236
    s_and_b32 s62, s41, 3
    s_lshl_b32 s62, s62, 3
    s_lshr_b32 s63, s41, 2
    s_add_u32 s62, s62, s63
    s_and_b32 s63, s42, 3
    s_lshl_b32 s63, s63, 1
    s_add_u32 s62, s62, s63
    s_lshl_b32 s62, s62, 1
    s_and_b32 s63, s40, 1
    s_add_u32 s62, s62, s63
    s_mul_i32 s62, s62, 28672
    s_lshr_b32 s63, s40, 1
    s_lshl_b32 s63, s63, 6
    s_add_u32 s63, s63, s47
    v_lshrrev_b32 v237, 5, v240
    v_lshlrev_b32 v237, 4, v237
    v_add_u32 v237, s63, v237
    v_and_b32 v252, 31, v240
    v_mul_u32_u24 v252, 896, v252
    v_add3_u32 v252, v252, v237, s62
    buffer_load_dwordx4 v[32:35], v252, s[4:7], 0 offen
    buffer_load_dwordx4 v[36:39], v252, s[4:7], 0 offen offset:32
    global_load_dwordx4 v[40:43], v237, s[96:97]
    global_load_dwordx4 v[44:47], v237, s[96:97] offset:32
    s_waitcnt vmcnt(10)
    ds_read_b64_tr_b16 v[16:17], v250 offset:16384
    ds_read_b64_tr_b16 v[18:19], v250 offset:16896
    ds_read_b64_tr_b16 v[20:21], v250 offset:20480
    ds_read_b64_tr_b16 v[22:23], v250 offset:20992
    ds_read_b64_tr_b16 v[24:25], v250 offset:24576
    ds_read_b64_tr_b16 v[26:27], v250 offset:25088
    ds_read_b64_tr_b16 v[28:29], v250 offset:28672
    ds_read_b64_tr_b16 v[30:31], v250 offset:29184
    buffer_load_dwordx4 v[80:83], v220, s[24:27], s20 offen
    s_add_u32 s62, s20, 7168
    buffer_load_dwordx4 v[84:87], v220, s[24:27], s62 offen
    s_add_u32 s20, s20, 14336
    s_cmp_eq_u32 s20, 157696
    s_cselect_b32 s20, 0, s20
    s_waitcnt lgkmcnt(7)
    v_dot2c_f32_bf16 v228, v59, v16
    v_dot2c_f32_bf16 v229, v59, v17
    s_waitcnt lgkmcnt(6)
    v_dot2c_f32_bf16 v228, v59, v18
    v_dot2c_f32_bf16 v229, v59, v19
    s_waitcnt lgkmcnt(5)
    v_dot2c_f32_bf16 v228, v59, v20
    v_dot2c_f32_bf16 v229, v59, v21
    s_waitcnt lgkmcnt(4)
    v_dot2c_f32_bf16 v228, v59, v22
    v_dot2c_f32_bf16 v229, v59, v23
    s_waitcnt vmcnt(10)
    buffer_load_dwordx4 v[88:91], v220, s[24:27], s20 offen
    s_add_u32 s62, s20, 7168
    buffer_load_dwordx4 v[92:95], v220, s[24:27], s62 offen
    s_add_u32 s20, s20, 14336
    s_cmp_eq_u32 s20, 157696
    s_cselect_b32 s20, 0, s20
    s_waitcnt vmcnt(10)
    ds_read_b64_tr_b16 v[0:1], v250 offset:49152
    ds_read_b64_tr_b16 v[2:3], v250 offset:49664
    ds_read_b64_tr_b16 v[4:5], v250 offset:53248
    ds_read_b64_tr_b16 v[6:7], v250 offset:53760
    buffer_load_dwordx4 v[96:99], v220, s[24:27], s20 offen
    s_add_u32 s62, s20, 7168
    buffer_load_dwordx4 v[100:103], v220, s[24:27], s62 offen
    s_add_u32 s20, s20, 14336
    s_cmp_eq_u32 s20, 157696
    s_cselect_b32 s20, 0, s20
    s_waitcnt lgkmcnt(7)
    v_dot2c_f32_bf16 v230, v59, v24
    v_dot2c_f32_bf16 v231, v59, v25
    s_waitcnt lgkmcnt(6)
    v_dot2c_f32_bf16 v230, v59, v26
    v_dot2c_f32_bf16 v231, v59, v27
    s_waitcnt lgkmcnt(5)
    v_dot2c_f32_bf16 v230, v59, v28
    v_dot2c_f32_bf16 v231, v59, v29
    s_waitcnt lgkmcnt(4)
    v_dot2c_f32_bf16 v230, v59, v30
    v_dot2c_f32_bf16 v231, v59, v31
    s_waitcnt lgkmcnt(3)
    v_dot2c_f32_bf16 v228, v59, v0
    v_dot2c_f32_bf16 v229, v59, v1
    s_waitcnt lgkmcnt(2)
    v_dot2c_f32_bf16 v228, v59, v2
    v_dot2c_f32_bf16 v229, v59, v3
    s_waitcnt lgkmcnt(1)
    v_dot2c_f32_bf16 v228, v59, v4
    v_dot2c_f32_bf16 v229, v59, v5
    s_waitcnt lgkmcnt(0)
    v_dot2c_f32_bf16 v228, v59, v6
    v_dot2c_f32_bf16 v229, v59, v7
    s_nop 2
    v_add_f32 v228, v228, v229
    v_and_b32 v72, 0xffff0000, v228
    v_sub_f32 v228, v228, v72
    v_and_b32 v73, 0xffff0000, v228
    v_sub_f32 v228, v228, v73
    v_lshrrev_b32 v72, 16, v72
    v_or_b32 v74, v72, v73
    v_lshrrev_b32 v228, 16, v228
    v_lshl_or_b32 v75, v224, 16, v228
    ds_write_b64 v253, v[74:75] offset:0
    ds_write_b32 v254, v224 offset:624
    ds_read_b128 v[76:79], v255 offset:496
    s_waitcnt lgkmcnt(0)
    v_or3_b32 v76, v76, v77, v78
    v_or_b32 v76, v76, v79
    v_cmp_ne_u32 vcc, 0, v76
    s_nop 4
    s_cbranch_vccnz SLOW_7
RET_8:
    s_waitcnt vmcnt(11)
    ds_read_b64_tr_b16 v[8:9], v250 offset:57344
    ds_read_b64_tr_b16 v[10:11], v250 offset:57856
    ds_read_b64_tr_b16 v[12:13], v250 offset:61440
    ds_read_b64_tr_b16 v[14:15], v250 offset:61952
    s_add_u32 m0, s50, 98304
    s_nop 0
    buffer_load_dwordx4 v247, s[8:11], s53 offen lds
    s_add_u32 s53, s53, 114688
    s_waitcnt vmcnt(11)
    s_add_u32 m0, s50, 102400
    s_nop 0
    buffer_load_dwordx4 v247, s[8:11], s53 offen lds
    s_add_u32 s53, s53, 114688
    s_cmp_eq_u32 s53, 1605632
    s_cselect_b32 s53, 0, s53
    s_add_u32 m0, s46, 112
    s_mov_b64 exec, 1
    buffer_load_dword v255, s[36:39], 0 offen lds
    s_mov_b64 exec, -1
    s_waitcnt vmcnt(11)
    s_add_u32 m0, s50, 106496
    s_nop 0
    buffer_load_dwordx4 v247, s[8:11], s53 offen lds
    s_add_u32 s53, s53, 114688
    s_waitcnt lgkmcnt(3)
    v_dot2c_f32_bf16 v230, v59, v8
    v_dot2c_f32_bf16 v231, v59, v9
    s_waitcnt lgkmcnt(2)
    v_dot2c_f32_bf16 v230, v59, v10
    v_dot2c_f32_bf16 v231, v59, v11
    s_waitcnt lgkmcnt(1)
    v_dot2c_f32_bf16 v230, v59, v12
    v_dot2c_f32_bf16 v231, v59, v13
    s_waitcnt lgkmcnt(0)
    v_dot2c_f32_bf16 v230, v59, v14
    v_dot2c_f32_bf16 v231, v59, v15
    s_nop 2
    v_add_f32 v230, v230, v231
    v_and_b32 v72, 0xffff0000, v230
    v_sub_f32 v230, v230, v72
    v_and_b32 v73, 0xffff0000, v230
    v_sub_f32 v230, v230, v73
    v_lshrrev_b32 v72, 16, v72
    v_or_b32 v74, v72, v73
    v_lshrrev_b32 v230, 16, v230
    v_lshl_or_b32 v75, v225, 16, v230
    ds_write_b64 v253, v[74:75] offset:2048
    ds_write_b32 v254, v224 offset:640
    s_waitcnt vmcnt(11)
    s_add_u32 m0, s50, 110592
    s_nop 0
    buffer_load_dwordx4 v247, s[8:11], s53 offen lds
    s_add_u32 s53, s53, 114688
    s_cmp_eq_u32 s53, 1605632
    s_cselect_b32 s53, 0, s53
    s_add_u32 m0, s46, 128
    s_mov_b64 exec, 1
    buffer_load_dword v255, s[36:39], 0 offen lds
    s_mov_b64 exec, -1
    s_waitcnt vmcnt(11)
    s_add_u32 m0, s50, 81920
    s_nop 0
    buffer_load_dwordx4 v247, s[8:11], s53 offen lds
    s_add_u32 s53, s53, 114688
    s_waitcnt vmcnt(11)
    s_add_u32 m0, s50, 86016
    s_nop 0
    buffer_load_dwordx4 v247, s[8:11], s53 offen lds
    s_add_u32 s53, s53, 114688
    s_cmp_eq_u32 s53, 1605632
    s_cselect_b32 s53, 0, s53
    s_add_u32 m0, s46, 144
    s_mov_b64 exec, 1
    buffer_load_dword v255, s[36:39], 0 offen lds
    s_mov_b64 exec, -1
    s_waitcnt vmcnt(11)
    s_add_u32 m0, s50, 90112
    s_nop 0
    buffer_load_dwordx4 v247, s[8:11], s53 offen lds
    s_add_u32 s53, s53, 114688
    s_waitcnt vmcnt(11)
    s_add_u32 m0, s50, 94208
    s_nop 0
    buffer_load_dwordx4 v247, s[8:11], s53 offen lds
    s_add_u32 s53, s53, 114688
    s_cmp_eq_u32 s53, 1605632
    s_cselect_b32 s53, 0, s53
    s_add_u32 m0, s46, 160
    s_mov_b64 exec, 1
    buffer_load_dword v255, s[36:39], 0 offen lds
    s_mov_b64 exec, -1
    ds_read_b128 v[76:79], v255 offset:512
    s_waitcnt vmcnt(10)
    ds_read_b64_tr_b16 v[16:17], v251 offset:16384
    ds_read_b64_tr_b16 v[18:19], v251 offset:16896
    ds_read_b64_tr_b16 v[20:21], v251 offset:20480
    ds_read_b64_tr_b16 v[22:23], v251 offset:20992
    buffer_load_dwordx4 v[104:107], v221, s[24:27], s21 offen
    s_add_u32 s62, s21, 7168
    buffer_load_dwordx4 v[108:111], v221, s[24:27], s62 offen
    s_add_u32 s21, s21, 14336
    s_cmp_eq_u32 s21, 229376
    s_cselect_b32 s21, 0, s21
    s_waitcnt vmcnt(10)
    buffer_load_dwordx4 v[112:115], v221, s[24:27], s21 offen
    s_add_u32 s62, s21, 7168
    buffer_load_dwordx4 v[116:119], v221, s[24:27], s62 offen
    s_add_u32 s21, s21, 14336
    s_cmp_eq_u32 s21, 229376
    s_cselect_b32 s21, 0, s21
    s_waitcnt vmcnt(10)
    ds_read_b64_tr_b16 v[24:25], v251 offset:24576
    ds_read_b64_tr_b16 v[26:27], v251 offset:25088
    ds_read_b64_tr_b16 v[28:29], v251 offset:28672
    ds_read_b64_tr_b16 v[30:31], v251 offset:29184
    buffer_load_dwordx4 v[120:123], v221, s[24:27], s21 offen
    s_add_u32 s62, s21, 7168
    buffer_load_dwordx4 v[124:127], v221, s[24:27], s62 offen
    s_add_u32 s21, s21, 14336
    s_cmp_eq_u32 s21, 229376
    s_cselect_b32 s21, 0, s21
    s_waitcnt lgkmcnt(7)
    v_dot2c_f32_bf16 v232, v59, v16
    v_dot2c_f32_bf16 v233, v59, v17
    s_waitcnt lgkmcnt(6)
    v_dot2c_f32_bf16 v232, v59, v18
    v_dot2c_f32_bf16 v233, v59, v19
    s_waitcnt lgkmcnt(5)
    v_dot2c_f32_bf16 v232, v59, v20
    v_dot2c_f32_bf16 v233, v59, v21
    s_waitcnt lgkmcnt(4)
    v_dot2c_f32_bf16 v232, v59, v22
    v_dot2c_f32_bf16 v233, v59, v23
    s_waitcnt lgkmcnt(3)
    v_dot2c_f32_bf16 v232, v59, v24
    v_dot2c_f32_bf16 v233, v59, v25
    s_waitcnt lgkmcnt(2)
    v_dot2c_f32_bf16 v232, v59, v26
    v_dot2c_f32_bf16 v233, v59, v27
    s_waitcnt lgkmcnt(1)
    v_dot2c_f32_bf16 v232, v59, v28
    v_dot2c_f32_bf16 v233, v59, v29
    s_waitcnt lgkmcnt(0)
    v_dot2c_f32_bf16 v232, v59, v30
    v_dot2c_f32_bf16 v233, v59, v31
    ds_read_b128 v[76:79], v255 offset:512
    s_waitcnt lgkmcnt(0)
    v_or3_b32 v76, v76, v77, v78
    v_or_b32 v76, v76, v79
    v_cmp_ne_u32 vcc, 0, v76
    s_nop 4
    s_cbranch_vccnz SLOW_9
RET_10:
    s_waitcnt vmcnt(11)
    s_add_u32 m0, s50, 131072
    s_nop 0
    buffer_load_dwordx4 v247, s[8:11], s53 offen lds
    s_add_u32 s53, s53, 114688
    s_waitcnt vmcnt(11)
    ds_read_b64_tr_b16 v[0:1], v251 offset:0
    ds_read_b64_tr_b16 v[2:3], v251 offset:512
    ds_read_b64_tr_b16 v[4:5], v251 offset:4096
    ds_read_b64_tr_b16 v[6:7], v251 offset:4608
    s_add_u32 m0, s50, 135168
    s_nop 0
    buffer_load_dwordx4 v247, s[8:11], s53 offen lds
    s_add_u32 s53, s53, 114688
    s_cmp_eq_u32 s53, 1605632
    s_cselect_b32 s53, 0, s53
    s_add_u32 m0, s46, 176
    s_mov_b64 exec, 1
    buffer_load_dword v255, s[36:39], 0 offen lds
    s_mov_b64 exec, -1
    s_waitcnt vmcnt(11)
    s_add_u32 m0, s50, 139264
    s_nop 0
    buffer_load_dwordx4 v247, s[8:11], s53 offen lds
    s_add_u32 s53, s53, 114688
    s_waitcnt vmcnt(11)
    ds_read_b64_tr_b16 v[8:9], v251 offset:8192
    ds_read_b64_tr_b16 v[10:11], v251 offset:8704
    ds_read_b64_tr_b16 v[12:13], v251 offset:12288
    ds_read_b64_tr_b16 v[14:15], v251 offset:12800
    s_add_u32 m0, s50, 143360
    s_nop 0
    buffer_load_dwordx4 v247, s[8:11], s53 offen lds
    s_add_u32 s53, s53, 114688
    s_cmp_eq_u32 s53, 1605632
    s_cselect_b32 s53, 0, s53
    s_add_u32 m0, s46, 192
    s_mov_b64 exec, 1
    buffer_load_dword v255, s[36:39], 0 offen lds
    s_mov_b64 exec, -1
    s_waitcnt lgkmcnt(7)
    v_dot2c_f32_bf16 v232, v59, v0
    v_dot2c_f32_bf16 v233, v59, v1
    s_waitcnt lgkmcnt(6)
    v_dot2c_f32_bf16 v232, v59, v2
    v_dot2c_f32_bf16 v233, v59, v3
    s_waitcnt lgkmcnt(5)
    v_dot2c_f32_bf16 v232, v59, v4
    v_dot2c_f32_bf16 v233, v59, v5
    s_waitcnt lgkmcnt(4)
    v_dot2c_f32_bf16 v232, v59, v6
    v_dot2c_f32_bf16 v233, v59, v7
    s_waitcnt vmcnt(11)
    s_add_u32 m0, s50, 114688
    s_nop 0
    buffer_load_dwordx4 v247, s[8:11], s53 offen lds
    s_add_u32 s53, s53, 114688
    s_waitcnt vmcnt(11)
    s_add_u32 m0, s50, 118784
    s_nop 0
    buffer_load_dwordx4 v247, s[8:11], s53 offen lds
    s_add_u32 s53, s53, 114688
    s_cmp_eq_u32 s53, 1605632
    s_cselect_b32 s53, 0, s53
    s_add_u32 m0, s46, 208
    s_mov_b64 exec, 1
    buffer_load_dword v255, s[36:39], 0 offen lds
    s_mov_b64 exec, -1
    s_waitcnt vmcnt(10)
    buffer_load_dwordx4 v[128:131], v221, s[24:27], s21 offen
    s_add_u32 s62, s21, 7168
    buffer_load_dwordx4 v[132:135], v221, s[24:27], s62 offen
    s_add_u32 s21, s21, 14336
    s_cmp_eq_u32 s21, 229376
    s_cselect_b32 s21, 0, s21
    s_waitcnt lgkmcnt(3)
    v_dot2c_f32_bf16 v232, v59, v8
    v_dot2c_f32_bf16 v233, v59, v9
    s_waitcnt lgkmcnt(2)
    v_dot2c_f32_bf16 v232, v59, v10
    v_dot2c_f32_bf16 v233, v59, v11
    s_waitcnt lgkmcnt(1)
    v_dot2c_f32_bf16 v232, v59, v12
    v_dot2c_f32_bf16 v233, v59, v13
    s_waitcnt lgkmcnt(0)
    v_dot2c_f32_bf16 v232, v59, v14
    v_dot2c_f32_bf16 v233, v59, v15
    s_waitcnt vmcnt(10)
    buffer_load_dwordx4 v[136:139], v222, s[24:27], 0 offen
    s_movk_i32 s62, 7168
    buffer_load_dwordx4 v[140:143], v222, s[24:27], s62 offen
    s_waitcnt vmcnt(10)
    ds_read_b64_tr_b16 v[16:17], v251 offset:49152
    ds_read_b64_tr_b16 v[18:19], v251 offset:49664
    ds_read_b64_tr_b16 v[20:21], v251 offset:53248
    ds_read_b64_tr_b16 v[22:23], v251 offset:53760
    buffer_load_dwordx4 v[144:147], v223, s[28:31], s22 offen
    s_add_u32 s62, s22, 7168
    buffer_load_dwordx4 v[148:151], v223, s[28:31], s62 offen
    s_add_u32 s22, s22, 14336
    s_waitcnt vmcnt(10)
    ds_read_b64_tr_b16 v[24:25], v251 offset:57344
    ds_read_b64_tr_b16 v[26:27], v251 offset:57856
    ds_read_b64_tr_b16 v[28:29], v251 offset:61440
    ds_read_b64_tr_b16 v[30:31], v251 offset:61952
    buffer_load_dwordx4 v[152:155], v223, s[28:31], s22 offen
    s_add_u32 s62, s22, 7168
    buffer_load_dwordx4 v[156:159], v223, s[28:31], s62 offen
    s_add_u32 s22, s22, 10752
    s_cmp_eq_u32 s22, 100352
    s_cselect_b32 s22, 0, s22
    v_mov_b32 v58, 0
    buffer_load_dwordx2 v[56:57], v58, s[36:39], 0 offen sc1
    s_waitcnt lgkmcnt(7)
    v_dot2c_f32_bf16 v232, v59, v16
    v_dot2c_f32_bf16 v233, v59, v17
    s_waitcnt lgkmcnt(6)
    v_dot2c_f32_bf16 v232, v59, v18
    v_dot2c_f32_bf16 v233, v59, v19
    s_waitcnt lgkmcnt(5)
    v_dot2c_f32_bf16 v232, v59, v20
    v_dot2c_f32_bf16 v233, v59, v21
    s_waitcnt lgkmcnt(4)
    v_dot2c_f32_bf16 v232, v59, v22
    v_dot2c_f32_bf16 v233, v59, v23
    s_waitcnt lgkmcnt(3)
    v_dot2c_f32_bf16 v232, v59, v24
    v_dot2c_f32_bf16 v233, v59, v25
    s_waitcnt lgkmcnt(2)
    v_dot2c_f32_bf16 v232, v59, v26
    v_dot2c_f32_bf16 v233, v59, v27
    s_waitcnt lgkmcnt(1)
    v_dot2c_f32_bf16 v232, v59, v28
    v_dot2c_f32_bf16 v233, v59, v29
    s_waitcnt lgkmcnt(0)
    v_dot2c_f32_bf16 v232, v59, v30
    v_dot2c_f32_bf16 v233, v59, v31
    s_waitcnt vmcnt(10)
    ds_read_b64_tr_b16 v[0:1], v251 offset:32768
    ds_read_b64_tr_b16 v[2:3], v251 offset:33280
    ds_read_b64_tr_b16 v[4:5], v251 offset:36864
    ds_read_b64_tr_b16 v[6:7], v251 offset:37376
    s_waitcnt lgkmcnt(3)
    v_dot2c_f32_bf16 v232, v59, v0
    v_dot2c_f32_bf16 v233, v59, v1
    s_waitcnt lgkmcnt(2)
    v_dot2c_f32_bf16 v232, v59, v2
    v_dot2c_f32_bf16 v233, v59, v3
    s_waitcnt lgkmcnt(1)
    v_dot2c_f32_bf16 v232, v59, v4
    v_dot2c_f32_bf16 v233, v59, v5
    s_waitcnt lgkmcnt(0)
    v_dot2c_f32_bf16 v232, v59, v6
    v_dot2c_f32_bf16 v233, v59, v7
    s_nop 2
    v_add_f32 v232, v232, v233
    v_and_b32 v72, 0xffff0000, v232
    v_sub_f32 v232, v232, v72
    v_and_b32 v73, 0xffff0000, v232
    v_sub_f32 v232, v232, v73
    v_lshrrev_b32 v72, 16, v72
    v_or_b32 v74, v72, v73
    v_lshrrev_b32 v232, 16, v232
    v_lshl_or_b32 v75, v226, 16, v232
    ds_write_b64 v253, v[74:75] offset:4096
    ds_write_b32 v254, v224 offset:656
    s_and_b32 s63, s2, 8
    s_cmp_eq_u32 s44, s63
    s_cbranch_scc1 SLOW_11
RET_12:
    s_cmp_eq_u32 s45, 7
    s_cbranch_scc1 L_pf
    s_mov_b32 s98, 0xffff0000
    s_mov_b32 s99, 0xff03
    v_mov_b32 v230, 0
    v_mov_b32 v231, 0
    s_setprio 0
    s_and_b32 s100, s41, 3
    s_lshl_b32 s100, s100, 3
    s_lshr_b32 s101, s41, 2
    s_add_u32 s100, s100, s101
    s_and_b32 s101, s42, 3
    s_lshl_b32 s101, s101, 1
    s_add_u32 s100, s100, s101
    v_lshlrev_b32 v244, 4, v240
    v_add_u32 v245, 200704, v244
    v_add_u32 v246, 32768, v244
    s_mul_i32 s48, s100, 401408
    s_add_u32 s48, s48, 86016
    s_lshl_b32 s49, s100, 16
    s_add_u32 s49, s49, 12845056
    s_mul_i32 s62, s40, 20480
    s_mov_b32 s59, s62
    v_add_u32 v247, s62, v244
    v_bfe_u32 v250, v240, 4, 1
    v_lshlrev_b32 v250, 5, v250
    v_and_b32 v248, 1, v240
    v_lshl_add_u32 v250, v248, 4, v250
    v_bfe_u32 v248, v240, 1, 1
    v_lshl_add_u32 v250, v248, 3, v250
    v_lshrrev_b32 v248, 5, v240
    v_bfe_u32 v249, v240, 2, 2
    v_lshl_add_u32 v248, v248, 3, v249
    v_lshl_add_u32 v250, v248, 7, v250
    v_lshrrev_b32 v249, 1, v249
    v_lshl_add_u32 v250, v249, 6, v250
    v_add_u32 v250, s62, v250
    s_lshr_b32 s62, s40, 1
    s_lshl_b32 s62, s62, 6
    v_xor_b32 v250, s62, v250
    v_xor_b32 v251, 64, v250
    s_bitcmp1_b32 s40, 0
    s_cselect_b64 vcc, -1, 0
    v_cndmask_b32 v241, v244, v245, vcc
    v_cndmask_b32 v242, v245, v244, vcc
    v_cndmask_b32 v243, v244, v246, vcc
    v_cndmask_b32 v239, v246, v244, vcc
    s_xor_b32 s58, s40, 1
    s_mul_i32 s57, s58, 20480
    s_add_u32 s57, s57, 0
    v_add_u32 v224, s57, v244
    s_xor_b32 s58, s40, 2
    s_mul_i32 s57, s58, 20480
    s_add_u32 s57, s57, 4096
    v_add_u32 v225, s57, v244
    s_xor_b32 s58, s40, 3
    s_mul_i32 s57, s58, 20480
    s_add_u32 s57, s57, 8192
    v_add_u32 v226, s57, v244
    ds_read_b128 v[232:235], v255 offset:560
    s_waitcnt lgkmcnt(0)
    v_or3_b32 v232, v232, v233, v234
    v_or_b32 v232, v232, v235
    v_cmp_ne_u32 vcc, 0, v232
    s_nop 4
    s_cbranch_vccnz SLOW_13
RET_14:
    ds_write_b128 v247, v[80:83] offset:0
    ds_write_b128 v247, v[84:87] offset:1024
    ds_write_b128 v247, v[88:91] offset:2048
    ds_write_b128 v247, v[92:95] offset:3072
    ds_write_b128 v247, v[96:99] offset:4096
    ds_write_b128 v247, v[100:103] offset:5120
    s_waitcnt vmcnt(6)
    s_add_u32 m0, s59, 6144
    s_add_u32 s62, s20, 6144
    buffer_load_dwordx4 v220, s[24:27], s20 offen lds
    buffer_load_dwordx4 v220, s[24:27], s62 offen offset:1024 lds
    s_add_u32 s20, s20, 14336
    s_cmp_eq_u32 s20, 157696
    s_cselect_b32 s20, 0, s20
    s_waitcnt vmcnt(6)
    s_add_u32 m0, s59, 8192
    s_add_u32 s62, s20, 6144
    buffer_load_dwordx4 v220, s[24:27], s20 offen lds
    buffer_load_dwordx4 v220, s[24:27], s62 offen offset:1024 lds
    s_add_u32 s20, s20, 14336
    s_cmp_eq_u32 s20, 157696
    s_cselect_b32 s20, 0, s20
    s_waitcnt vmcnt(6)
    s_add_u32 m0, s59, 10240
    s_add_u32 s62, s20, 6144
    buffer_load_dwordx4 v220, s[24:27], s20 offen lds
    buffer_load_dwordx4 v220, s[24:27], s62 offen offset:1024 lds
    s_add_u32 s20, s20, 14336
    s_cmp_eq_u32 s20, 157696
    s_cselect_b32 s20, 0, s20
    s_waitcnt vmcnt(6)
    s_add_u32 m0, s59, 12288
    s_add_u32 s62, s20, 6144
    buffer_load_dwordx4 v220, s[24:27], s20 offen lds
    buffer_load_dwordx4 v220, s[24:27], s62 offen offset:1024 lds
    s_add_u32 s20, s20, 14336
    s_cmp_eq_u32 s20, 157696
    s_cselect_b32 s20, 0, s20
    s_waitcnt vmcnt(6)
    s_add_u32 m0, s59, 14336
    s_add_u32 s62, s20, 6144
    buffer_load_dwordx4 v220, s[24:27], s20 offen lds
    buffer_load_dwordx4 v220, s[24:27], s62 offen offset:1024 lds
    s_add_u32 s20, s20, 14336
    s_cmp_eq_u32 s20, 157696
    s_cselect_b32 s20, 0, s20
    s_waitcnt vmcnt(6)
    s_add_u32 m0, s59, 16384
    s_add_u32 s62, s20, 6144
    buffer_load_dwordx4 v220, s[24:27], s20 offen lds
    buffer_load_dwordx4 v220, s[24:27], s62 offen offset:1024 lds
    s_add_u32 s20, s20, 14336
    s_cmp_eq_u32 s20, 157696
    s_cselect_b32 s20, 0, s20
    s_waitcnt vmcnt(6)
    s_add_u32 m0, s59, 18432
    s_add_u32 s62, s20, 6144
    buffer_load_dwordx4 v220, s[24:27], s20 offen lds
    buffer_load_dwordx4 v220, s[24:27], s62 offen offset:1024 lds
    s_add_u32 s20, s20, 14336
    s_cmp_eq_u32 s20, 157696
    s_cselect_b32 s20, 0, s20
    s_waitcnt lgkmcnt(0)
    ds_read_b64_tr_b16 v[64:65], v250 offset:0
    ds_read_b64_tr_b16 v[66:67], v250 offset:512
    ds_read_b64_tr_b16 v[68:69], v251 offset:0
    ds_read_b64_tr_b16 v[70:71], v251 offset:512
    v_lshlrev_b32 v0, 16, v32
    v_and_b32 v1, 0xffff0000, v32
    v_lshlrev_b32 v248, 16, v40
    v_and_b32 v249, 0xffff0000, v40
    v_add_f32 v0, v0, v248
    v_add_f32 v1, v1, v249
    v_lshlrev_b32 v2, 16, v33
    v_and_b32 v3, 0xffff0000, v33
    v_lshlrev_b32 v248, 16, v41
    v_and_b32 v249, 0xffff0000, v41
    v_add_f32 v2, v2, v248
    v_add_f32 v3, v3, v249
    v_lshlrev_b32 v4, 16, v34
    v_and_b32 v5, 0xffff0000, v34
    v_lshlrev_b32 v248, 16, v42
    v_and_b32 v249, 0xffff0000, v42
    v_add_f32 v4, v4, v248
    v_add_f32 v5, v5, v249
    v_lshlrev_b32 v6, 16, v35
    v_and_b32 v7, 0xffff0000, v35
    v_lshlrev_b32 v248, 16, v43
    v_and_b32 v249, 0xffff0000, v43
    v_add_f32 v6, v6, v248
    v_add_f32 v7, v7, v249
    v_lshlrev_b32 v8, 16, v36
    v_and_b32 v9, 0xffff0000, v36
    v_lshlrev_b32 v248, 16, v44
    v_and_b32 v249, 0xffff0000, v44
    v_add_f32 v8, v8, v248
    v_add_f32 v9, v9, v249
    v_lshlrev_b32 v10, 16, v37
    v_and_b32 v11, 0xffff0000, v37
    v_lshlrev_b32 v248, 16, v45
    v_and_b32 v249, 0xffff0000, v45
    v_add_f32 v10, v10, v248
    v_add_f32 v11, v11, v249
    v_lshlrev_b32 v12, 16, v38
    v_and_b32 v13, 0xffff0000, v38
    v_lshlrev_b32 v248, 16, v46
    v_and_b32 v249, 0xffff0000, v46
    v_add_f32 v12, v12, v248
    v_add_f32 v13, v13, v249
    v_lshlrev_b32 v14, 16, v39
    v_and_b32 v15, 0xffff0000, v39
    v_lshlrev_b32 v248, 16, v47
    v_and_b32 v249, 0xffff0000, v47
    v_add_f32 v14, v14, v248
    v_add_f32 v15, v15, v249
    v_readfirstlane_b32 s60, v56
    v_readfirstlane_b32 s61, v57
    s_cmp_lg_u32 s60, 0
    s_cbranch_scc0 SLOW_15
RET_16:
    s_waitcnt vmcnt(6)
    buffer_load_dwordx4 v[160:163], v220, s[24:27], s20 offen
    s_add_u32 s62, s20, 7168
    buffer_load_dwordx4 v[164:167], v220, s[24:27], s62 offen
    s_add_u32 s20, s20, 14336
    s_cmp_eq_u32 s20, 157696
    s_cselect_b32 s20, 0, s20
    s_waitcnt vmcnt(6)
    buffer_load_dwordx4 v[168:171], v221, s[24:27], s21 offen
    s_add_u32 s62, s21, 7168
    buffer_load_dwordx4 v[172:175], v221, s[24:27], s62 offen
    s_add_u32 s21, s21, 14336
    s_cmp_eq_u32 s21, 229376
    s_cselect_b32 s21, 0, s21
    ds_read_b128 v[232:235], v255 offset:576
    s_waitcnt lgkmcnt(0)
    v_or3_b32 v232, v232, v233, v234
    v_or_b32 v232, v232, v235
    v_cmp_ne_u32 vcc, 0, v232
    s_nop 4
    s_cbranch_vccnz SLOW_17
RET_18:
    s_and_b32 exec_lo, s98, 16711680
    s_and_b32 exec_hi, s99, 0
    s_or_b32 exec_lo, exec_lo, 65536
    buffer_load_dwordx2 v[230:231], v238, s[16:19], 0 offen sc1
    s_mov_b64 exec, -1
    buffer_load_dwordx4 v[176:179], v221, s[24:27], s21 offen
    s_add_u32 s62, s21, 7168
    buffer_load_dwordx4 v[180:183], v221, s[24:27], s62 offen
    s_add_u32 s21, s21, 14336
    s_cmp_eq_u32 s21, 229376
    s_cselect_b32 s21, 0, s21
    buffer_load_dwordx4 v[184:187], v221, s[24:27], s21 offen
    s_add_u32 s62, s21, 7168
    buffer_load_dwordx4 v[188:191], v221, s[24:27], s62 offen
    s_add_u32 s21, s21, 14336
    s_cmp_eq_u32 s21, 229376
    s_cselect_b32 s21, 0, s21
    buffer_load_dwordx4 v[192:195], v221, s[24:27], s21 offen
    s_add_u32 s62, s21, 7168
    buffer_load_dwordx4 v[196:199], v221, s[24:27], s62 offen
    s_add_u32 s21, s21, 14336
    s_cmp_eq_u32 s21, 229376
    s_cselect_b32 s21, 0, s21
    buffer_load_dwordx4 v[200:203], v221, s[24:27], s21 offen
    s_add_u32 s62, s21, 7168
    buffer_load_dwordx4 v[204:207], v221, s[24:27], s62 offen
    s_add_u32 s21, s21, 14336
    s_cmp_eq_u32 s21, 229376
    s_cselect_b32 s21, 0, s21
    s_waitcnt vmcnt(8)
    v_cmp_ne_u64 vcc, s[60:61], v[230:231]
    s_nop 0
    s_and_b64 s[98:99], s[98:99], vcc
    s_and_b32 s62, s98, 16711680
    s_cbranch_scc1 SLOW_19
RET_20:
    s_mul_i32 s10, s40, 11264
    s_add_u32 s10, s10, s48
    s_add_u32 s9, s10, 11264
    s_bfe_u32 s8, s23, 524288
    s_lshl_b32 s8, s8, 10
    s_add_u32 s8, s8, s10
    buffer_load_dwordx4 v[208:211], v241, s[16:19], s8 offen sc1
    buffer_load_dwordx4 v[212:215], v242, s[16:19], s8 offen sc1
    s_add_u32 s8, s8, 1024
    s_cmp_eq_u32 s8, s9
    s_cselect_b32 s8, s10, s8
    buffer_load_dwordx4 v[216:219], v241, s[16:19], s8 offen sc1
    buffer_load_dwordx4 v[80:83], v242, s[16:19], s8 offen sc1
    s_add_u32 s8, s8, 1024
    s_cmp_eq_u32 s8, s9
    s_cselect_b32 s8, s10, s8
    s_waitcnt vmcnt(3)
    v_mfma_f32_32x32x16_bf16 v[0:15], v[64:67], v[208:211], v[0:15]
    v_mfma_f32_32x32x16_bf16 v[32:47], v[68:71], v[208:211], 0
    ds_read_b64_tr_b16 v[72:73], v250 offset:2048
    ds_read_b64_tr_b16 v[74:75], v250 offset:2560
    ds_read_b64_tr_b16 v[76:77], v251 offset:2048
    ds_read_b64_tr_b16 v[78:79], v251 offset:2560
    s_waitcnt vmcnt(2)
    v_mfma_f32_32x32x16_bf16 v[16:31], v[64:67], v[212:215], 0
    buffer_load_dwordx4 v[84:87], v241, s[16:19], s8 offen sc1
    buffer_load_dwordx4 v[88:91], v242, s[16:19], s8 offen sc1
    s_add_u32 s8, s8, 1024
    s_cmp_eq_u32 s8, s9
    s_cselect_b32 s8, s10, s8
    v_mfma_f32_32x32x16_bf16 v[48:63], v[68:71], v[212:215], 0
    buffer_load_dwordx4 v[92:95], v241, s[16:19], s8 offen sc1
    buffer_load_dwordx4 v[96:99], v242, s[16:19], s8 offen sc1
    s_add_u32 s8, s8, 1024
    s_cmp_eq_u32 s8, s9
    s_cselect_b32 s8, s10, s8
    s_waitcnt vmcnt(5) lgkmcnt(2)
    v_mfma_f32_32x32x16_bf16 v[0:15], v[72:75], v[216:219], v[0:15]
    s_waitcnt lgkmcnt(0)
    v_mfma_f32_32x32x16_bf16 v[32:47], v[76:79], v[216:219], v[32:47]
    ds_read_b64_tr_b16 v[64:65], v250 offset:4096
    ds_read_b64_tr_b16 v[66:67], v250 offset:4608
    ds_read_b64_tr_b16 v[68:69], v251 offset:4096
    ds_read_b64_tr_b16 v[70:71], v251 offset:4608
    s_waitcnt vmcnt(4)
    v_mfma_f32_32x32x16_bf16 v[16:31], v[72:75], v[80:83], v[16:31]
    buffer_load_dwordx4 v[100:103], v241, s[16:19], s8 offen sc1
    buffer_load_dwordx4 v[208:211], v242, s[16:19], s8 offen sc1
    s_add_u32 s8, s8, 1024
    s_cmp_eq_u32 s8, s9
    s_cselect_b32 s8, s10, s8
    v_mfma_f32_32x32x16_bf16 v[48:63], v[76:79], v[80:83], v[48:63]
    ds_write_b128 v247, v[160:163] offset:0
    ds_write_b128 v247, v[164:167] offset:1024
    s_waitcnt vmcnt(5) lgkmcnt(4)
    v_mfma_f32_32x32x16_bf16 v[0:15], v[64:67], v[84:87], v[0:15]
    s_waitcnt lgkmcnt(2)
    v_mfma_f32_32x32x16_bf16 v[32:47], v[68:71], v[84:87], v[32:47]
    ds_read_b64_tr_b16 v[72:73], v250 offset:6144
    ds_read_b64_tr_b16 v[74:75], v250 offset:6656
    ds_read_b64_tr_b16 v[76:77], v251 offset:6144
    ds_read_b64_tr_b16 v[78:79], v251 offset:6656
    s_waitcnt vmcnt(4)
    v_mfma_f32_32x32x16_bf16 v[16:31], v[64:67], v[88:91], v[16:31]
    buffer_load_dwordx4 v[212:215], v241, s[16:19], s8 offen sc1
    buffer_load_dwordx4 v[216:219], v242, s[16:19], s8 offen sc1
    s_add_u32 s8, s8, 1024
    s_cmp_eq_u32 s8, s9
    s_cselect_b32 s8, s10, s8
    v_mfma_f32_32x32x16_bf16 v[48:63], v[68:71], v[88:91], v[48:63]
    ds_write_b128 v247, v[104:107] offset:2048
    ds_write_b128 v247, v[108:111] offset:3072
    s_waitcnt vmcnt(5) lgkmcnt(4)
    v_mfma_f32_32x32x16_bf16 v[0:15], v[72:75], v[92:95], v[0:15]
    s_waitcnt lgkmcnt(2)
    v_mfma_f32_32x32x16_bf16 v[32:47], v[76:79], v[92:95], v[32:47]
    ds_read_b64_tr_b16 v[64:65], v250 offset:8192
    ds_read_b64_tr_b16 v[66:67], v250 offset:8704
    ds_read_b64_tr_b16 v[68:69], v251 offset:8192
    ds_read_b64_tr_b16 v[70:71], v251 offset:8704
    s_waitcnt vmcnt(4)
    v_mfma_f32_32x32x16_bf16 v[16:31], v[72:75], v[96:99], v[16:31]
    buffer_load_dwordx4 v[80:83], v241, s[16:19], s8 offen sc1
    buffer_load_dwordx4 v[84:87], v242, s[16:19], s8 offen sc1
    s_add_u32 s8, s8, 1024
    s_cmp_eq_u32 s8, s9
    s_cselect_b32 s8, s10, s8
    v_mfma_f32_32x32x16_bf16 v[48:63], v[76:79], v[96:99], v[48:63]
    buffer_load_dwordx4 v[88:91], v241, s[16:19], s8 offen sc1
    buffer_load_dwordx4 v[160:163], v242, s[16:19], s8 offen sc1
    s_add_u32 s8, s8, 1024
    s_cmp_eq_u32 s8, s9
    s_cselect_b32 s8, s10, s8
    ds_write_b128 v247, v[112:115] offset:4096
    ds_write_b128 v247, v[116:119] offset:5120
    s_waitcnt vmcnt(7) lgkmcnt(4)
    v_mfma_f32_32x32x16_bf16 v[0:15], v[64:67], v[100:103], v[0:15]
    s_waitcnt lgkmcnt(2)
    v_mfma_f32_32x32x16_bf16 v[32:47], v[68:71], v[100:103], v[32:47]
    ds_read_b64_tr_b16 v[72:73], v250 offset:10240
    ds_read_b64_tr_b16 v[74:75], v250 offset:10752
    ds_read_b64_tr_b16 v[76:77], v251 offset:10240
    ds_read_b64_tr_b16 v[78:79], v251 offset:10752
    s_waitcnt vmcnt(6)
    v_mfma_f32_32x32x16_bf16 v[16:31], v[64:67], v[208:211], v[16:31]
    buffer_load_dwordx4 v[164:167], v241, s[16:19], s8 offen sc1
    buffer_load_dwordx4 v[92:95], v242, s[16:19], s8 offen sc1
    s_add_u32 s8, s8, 1024
    s_cmp_eq_u32 s8, s9
    s_cselect_b32 s8, s10, s8
    v_mfma_f32_32x32x16_bf16 v[48:63], v[68:71], v[208:211], v[48:63]
    buffer_load_dwordx4 v[96:99], v241, s[16:19], s8 offen sc1
    buffer_load_dwordx4 v[104:107], v242, s[16:19], s8 offen sc1
    s_add_u32 s8, s8, 1024
    s_cmp_eq_u32 s8, s9
    s_cselect_b32 s8, s10, s8
    ds_write_b128 v247, v[120:123] offset:6144
    ds_write_b128 v247, v[124:127] offset:7168
    s_and_b32 exec_lo, s98, 4278190080
    s_and_b32 exec_hi, s99, 0
    s_or_b32 exec_lo, exec_lo, 16777216
    buffer_load_dwordx2 v[230:231], v238, s[16:19], 0 offen sc1
    s_mov_b64 exec, -1
    s_waitcnt vmcnt(10) lgkmcnt(4)
    v_mfma_f32_32x32x16_bf16 v[0:15], v[72:75], v[212:215], v[0:15]
    s_waitcnt lgkmcnt(2)
    v_mfma_f32_32x32x16_bf16 v[32:47], v[76:79], v[212:215], v[32:47]
    ds_read_b64_tr_b16 v[64:65], v250 offset:12288
    ds_read_b64_tr_b16 v[66:67], v250 offset:12800
    ds_read_b64_tr_b16 v[68:69], v251 offset:12288
    ds_read_b64_tr_b16 v[70:71], v251 offset:12800
    s_waitcnt vmcnt(9)
    v_mfma_f32_32x32x16_bf16 v[16:31], v[72:75], v[216:219], v[16:31]
    buffer_load_dwordx4 v[108:111], v241, s[16:19], s8 offen sc1
    buffer_load_dwordx4 v[100:103], v242, s[16:19], s8 offen sc1
    s_add_u32 s8, s8, 1024
    s_cmp_eq_u32 s8, s9
    s_cselect_b32 s8, s10, s8
    v_mfma_f32_32x32x16_bf16 v[48:63], v[76:79], v[216:219], v[48:63]
    ds_write_b128 v247, v[128:131] offset:8192
    ds_write_b128 v247, v[132:135] offset:9216
    s_waitcnt vmcnt(10) lgkmcnt(4)
    v_mfma_f32_32x32x16_bf16 v[0:15], v[64:67], v[80:83], v[0:15]
    s_waitcnt lgkmcnt(2)
    v_mfma_f32_32x32x16_bf16 v[32:47], v[68:71], v[80:83], v[32:47]
    ds_read_b64_tr_b16 v[72:73], v250 offset:14336
    ds_read_b64_tr_b16 v[74:75], v250 offset:14848
    ds_read_b64_tr_b16 v[76:77], v251 offset:14336
    ds_read_b64_tr_b16 v[78:79], v251 offset:14848
    s_waitcnt vmcnt(9)
    v_mfma_f32_32x32x16_bf16 v[16:31], v[64:67], v[84:87], v[16:31]
    buffer_load_dwordx4 v[208:211], v221, s[24:27], s21 offen
    s_add_u32 s62, s21, 7168
    buffer_load_dwordx4 v[112:115], v221, s[24:27], s62 offen
    s_add_u32 s21, s21, 14336
    s_cmp_eq_u32 s21, 229376
    s_cselect_b32 s21, 0, s21
    v_mfma_f32_32x32x16_bf16 v[48:63], v[68:71], v[84:87], v[48:63]
    ds_write_b128 v247, v[168:171] offset:10240
    ds_write_b128 v247, v[172:175] offset:11264
    s_waitcnt vmcnt(10) lgkmcnt(4)
    v_mfma_f32_32x32x16_bf16 v[0:15], v[72:75], v[88:91], v[0:15]
    s_waitcnt lgkmcnt(2)
    v_mfma_f32_32x32x16_bf16 v[32:47], v[76:79], v[88:91], v[32:47]
    ds_read_b64_tr_b16 v[64:65], v250 offset:16384
    ds_read_b64_tr_b16 v[66:67], v250 offset:16896
    ds_read_b64_tr_b16 v[68:69], v251 offset:16384
    ds_read_b64_tr_b16 v[70:71], v251 offset:16896
    s_waitcnt vmcnt(9)
    v_mfma_f32_32x32x16_bf16 v[16:31], v[72:75], v[160:163], v[16:31]
    buffer_load_dwordx4 v[116:119], v221, s[24:27], s21 offen
    s_add_u32 s62, s21, 7168
    buffer_load_dwordx4 v[212:215], v221, s[24:27], s62 offen
    s_add_u32 s21, s21, 14336
    s_cmp_eq_u32 s21, 229376
    s_cselect_b32 s21, 0, s21
    v_mfma_f32_32x32x16_bf16 v[48:63], v[76:79], v[160:163], v[48:63]
    ds_write_b128 v247, v[176:179] offset:12288
    ds_write_b128 v247, v[180:183] offset:13312
    s_waitcnt vmcnt(6)
    v_cmp_ne_u64 vcc, s[60:61], v[230:231]
    s_nop 0
    s_and_b64 s[98:99], s[98:99], vcc
    s_and_b32 s62, s98, 4278190080
    s_cbranch_scc1 SLOW_21
RET_22:
    s_mul_i32 s10, s40, 16384
    s_add_u32 s10, s10, s48
    s_add_u32 s10, s10, 45056
    s_add_u32 s9, s10, 16384
    s_bfe_u32 s8, s23, 524296
    s_lshl_b32 s8, s8, 10
    s_add_u32 s8, s8, s10
    buffer_load_dwordx4 v[216:219], v241, s[16:19], s8 offen sc1
    buffer_load_dwordx4 v[120:123], v242, s[16:19], s8 offen sc1
    s_add_u32 s8, s8, 1024
    s_cmp_eq_u32 s8, s9
    s_cselect_b32 s8, s10, s8
    buffer_load_dwordx4 v[124:127], v241, s[16:19], s8 offen sc1
    buffer_load_dwordx4 v[80:83], v242, s[16:19], s8 offen sc1
    s_add_u32 s8, s8, 1024
    s_cmp_eq_u32 s8, s9
    s_cselect_b32 s8, s10, s8
    buffer_load_dwordx4 v[84:87], v241, s[16:19], s8 offen sc1
    buffer_load_dwordx4 v[128:131], v242, s[16:19], s8 offen sc1
    s_add_u32 s8, s8, 1024
    s_cmp_eq_u32 s8, s9
    s_cselect_b32 s8, s10, s8
    s_waitcnt lgkmcnt(4)
    v_mfma_f32_32x32x16_bf16 v[0:15], v[64:67], v[164:167], v[0:15]
    s_waitcnt lgkmcnt(2)
    v_mfma_f32_32x32x16_bf16 v[32:47], v[68:71], v[164:167], v[32:47]
    ds_read_b64_tr_b16 v[72:73], v250 offset:18432
    ds_read_b64_tr_b16 v[74:75], v250 offset:18944
    ds_read_b64_tr_b16 v[76:77], v251 offset:18432
    ds_read_b64_tr_b16 v[78:79], v251 offset:18944
    v_mfma_f32_32x32x16_bf16 v[16:31], v[64:67], v[92:95], v[16:31]
    v_mfma_f32_32x32x16_bf16 v[48:63], v[68:71], v[92:95], v[48:63]
    ds_write_b128 v247, v[184:187] offset:14336
    ds_write_b128 v247, v[188:191] offset:15360
    s_waitcnt lgkmcnt(4)
    v_mfma_f32_32x32x16_bf16 v[0:15], v[72:75], v[96:99], v[0:15]
    s_waitcnt lgkmcnt(2)
    v_mfma_f32_32x32x16_bf16 v[32:47], v[76:79], v[96:99], v[32:47]
    ds_read_b64_tr_b16 v[64:65], v250 offset:0
    ds_read_b64_tr_b16 v[66:67], v250 offset:512
    ds_read_b64_tr_b16 v[68:69], v251 offset:0
    ds_read_b64_tr_b16 v[70:71], v251 offset:512
    v_mfma_f32_32x32x16_bf16 v[16:31], v[72:75], v[104:107], v[16:31]
    v_mfma_f32_32x32x16_bf16 v[48:63], v[76:79], v[104:107], v[48:63]
    ds_write_b128 v247, v[192:195] offset:16384
    ds_write_b128 v247, v[196:199] offset:17408
    s_waitcnt vmcnt(11) lgkmcnt(4)
    v_mfma_f32_32x32x16_bf16 v[0:15], v[64:67], v[108:111], v[0:15]
    s_waitcnt lgkmcnt(2)
    v_mfma_f32_32x32x16_bf16 v[32:47], v[68:71], v[108:111], v[32:47]
    ds_read_b64_tr_b16 v[72:73], v250 offset:2048
    ds_read_b64_tr_b16 v[74:75], v250 offset:2560
    ds_read_b64_tr_b16 v[76:77], v251 offset:2048
    ds_read_b64_tr_b16 v[78:79], v251 offset:2560
    s_waitcnt vmcnt(10)
    v_mfma_f32_32x32x16_bf16 v[16:31], v[64:67], v[100:103], v[16:31]
    buffer_load_dwordx4 v[132:135], v241, s[16:19], s8 offen sc1
    buffer_load_dwordx4 v[88:91], v242, s[16:19], s8 offen sc1
    s_add_u32 s8, s8, 1024
    s_cmp_eq_u32 s8, s9
    s_cselect_b32 s8, s10, s8
    v_mfma_f32_32x32x16_bf16 v[48:63], v[68:71], v[100:103], v[48:63]
    ds_write_b128 v247, v[200:203] offset:18432
    ds_write_b128 v247, v[204:207] offset:19456
    s_waitcnt vmcnt(7) lgkmcnt(4)
    v_mfma_f32_32x32x16_bf16 v[0:15], v[72:75], v[216:219], v[0:15]
    s_waitcnt lgkmcnt(2)
    v_mfma_f32_32x32x16_bf16 v[32:47], v[76:79], v[216:219], v[32:47]
    ds_read_b64_tr_b16 v[64:65], v250 offset:4096
    ds_read_b64_tr_b16 v[66:67], v250 offset:4608
    ds_read_b64_tr_b16 v[68:69], v251 offset:4096
    ds_read_b64_tr_b16 v[70:71], v251 offset:4608
    s_waitcnt vmcnt(6)
    v_mfma_f32_32x32x16_bf16 v[16:31], v[72:75], v[120:123], v[16:31]
    buffer_load_dwordx4 v[160:163], v241, s[16:19], s8 offen sc1
    buffer_load_dwordx4 v[168:171], v242, s[16:19], s8 offen sc1
    s_add_u32 s8, s8, 1024
    s_cmp_eq_u32 s8, s9
    s_cselect_b32 s8, s10, s8
    v_mfma_f32_32x32x16_bf16 v[48:63], v[76:79], v[120:123], v[48:63]
    buffer_load_dwordx4 v[172:175], v241, s[16:19], s8 offen sc1
    buffer_load_dwordx4 v[164:167], v242, s[16:19], s8 offen sc1
    s_add_u32 s8, s8, 1024
    s_cmp_eq_u32 s8, s9
    s_cselect_b32 s8, s10, s8
    ds_write_b128 v247, v[208:211] offset:0
    ds_write_b128 v247, v[112:115] offset:1024
    buffer_load_dwordx4 v[92:95], v241, s[16:19], s8 offen sc1
    buffer_load_dwordx4 v[176:179], v242, s[16:19], s8 offen sc1
    s_add_u32 s8, s8, 1024
    s_cmp_eq_u32 s8, s9
    s_cselect_b32 s8, s10, s8
    s_waitcnt vmcnt(11) lgkmcnt(4)
    v_mfma_f32_32x32x16_bf16 v[0:15], v[64:67], v[124:127], v[0:15]
    s_waitcnt lgkmcnt(2)
    v_mfma_f32_32x32x16_bf16 v[32:47], v[68:71], v[124:127], v[32:47]
    ds_read_b64_tr_b16 v[72:73], v250 offset:6144
    ds_read_b64_tr_b16 v[74:75], v250 offset:6656
    ds_read_b64_tr_b16 v[76:77], v251 offset:6144
    ds_read_b64_tr_b16 v[78:79], v251 offset:6656
    s_waitcnt vmcnt(10)
    v_mfma_f32_32x32x16_bf16 v[16:31], v[64:67], v[80:83], v[16:31]
    buffer_load_dwordx4 v[180:183], v221, s[24:27], s21 offen
    s_add_u32 s62, s21, 7168
    buffer_load_dwordx4 v[96:99], v221, s[24:27], s62 offen
    s_add_u32 s21, s21, 14336
    s_cmp_eq_u32 s21, 229376
    s_cselect_b32 s21, 0, s21
    v_mfma_f32_32x32x16_bf16 v[48:63], v[68:71], v[80:83], v[48:63]
    ds_write_b128 v247, v[116:119] offset:2048
    ds_write_b128 v247, v[212:215] offset:3072
    s_waitcnt vmcnt(11) lgkmcnt(4)
    v_mfma_f32_32x32x16_bf16 v[0:15], v[72:75], v[84:87], v[0:15]
    s_waitcnt lgkmcnt(2)
    v_mfma_f32_32x32x16_bf16 v[32:47], v[76:79], v[84:87], v[32:47]
    ds_read_b64_tr_b16 v[64:65], v250 offset:8192
    ds_read_b64_tr_b16 v[66:67], v250 offset:8704
    ds_read_b64_tr_b16 v[68:69], v251 offset:8192
    ds_read_b64_tr_b16 v[70:71], v251 offset:8704
    s_waitcnt vmcnt(10)
    v_mfma_f32_32x32x16_bf16 v[16:31], v[72:75], v[128:131], v[16:31]
    buffer_load_dwordx4 v[104:107], v241, s[16:19], s8 offen sc1
    buffer_load_dwordx4 v[184:187], v242, s[16:19], s8 offen sc1
    s_add_u32 s8, s8, 1024
    s_cmp_eq_u32 s8, s9
    s_cselect_b32 s8, s10, s8
    v_mfma_f32_32x32x16_bf16 v[48:63], v[76:79], v[128:131], v[48:63]
    s_waitcnt vmcnt(11) lgkmcnt(2)
    v_mfma_f32_32x32x16_bf16 v[0:15], v[64:67], v[132:135], v[0:15]
    s_waitcnt lgkmcnt(0)
    v_mfma_f32_32x32x16_bf16 v[32:47], v[68:71], v[132:135], v[32:47]
    ds_read_b64_tr_b16 v[72:73], v250 offset:10240
    ds_read_b64_tr_b16 v[74:75], v250 offset:10752
    ds_read_b64_tr_b16 v[76:77], v251 offset:10240
    ds_read_b64_tr_b16 v[78:79], v251 offset:10752
    s_waitcnt vmcnt(10)
    v_mfma_f32_32x32x16_bf16 v[16:31], v[64:67], v[88:91], v[16:31]
    buffer_load_dwordx4 v[188:191], v221, s[24:27], s21 offen
    s_add_u32 s62, s21, 7168
    buffer_load_dwordx4 v[108:111], v221, s[24:27], s62 offen
    s_add_u32 s21, s21, 14336
    s_cmp_eq_u32 s21, 229376
    s_cselect_b32 s21, 0, s21
    v_mfma_f32_32x32x16_bf16 v[48:63], v[68:71], v[88:91], v[48:63]
    s_waitcnt vmcnt(11) lgkmcnt(2)
    v_mfma_f32_32x32x16_bf16 v[0:15], v[72:75], v[160:163], v[0:15]
    s_waitcnt lgkmcnt(0)
    v_mfma_f32_32x32x16_bf16 v[32:47], v[76:79], v[160:163], v[32:47]
    ds_read_b64_tr_b16 v[64:65], v250 offset:12288
    ds_read_b64_tr_b16 v[66:67], v250 offset:12800
    ds_read_b64_tr_b16 v[68:69], v251 offset:12288
    ds_read_b64_tr_b16 v[70:71], v251 offset:12800
    s_waitcnt vmcnt(10)
    v_mfma_f32_32x32x16_bf16 v[16:31], v[72:75], v[168:171], v[16:31]
    buffer_load_dwordx4 v[100:103], v241, s[16:19], s8 offen sc1
    buffer_load_dwordx4 v[192:195], v242, s[16:19], s8 offen sc1
    s_add_u32 s8, s8, 1024
    s_cmp_eq_u32 s8, s9
    s_cselect_b32 s8, s10, s8
    v_mfma_f32_32x32x16_bf16 v[48:63], v[76:79], v[168:171], v[48:63]
    s_waitcnt vmcnt(11) lgkmcnt(2)
    v_mfma_f32_32x32x16_bf16 v[0:15], v[64:67], v[172:175], v[0:15]
    s_waitcnt lgkmcnt(0)
    v_mfma_f32_32x32x16_bf16 v[32:47], v[68:71], v[172:175], v[32:47]
    ds_read_b64_tr_b16 v[72:73], v250 offset:14336
    ds_read_b64_tr_b16 v[74:75], v250 offset:14848
    ds_read_b64_tr_b16 v[76:77], v251 offset:14336
    ds_read_b64_tr_b16 v[78:79], v251 offset:14848
    s_waitcnt vmcnt(10)
    v_mfma_f32_32x32x16_bf16 v[16:31], v[64:67], v[164:167], v[16:31]
    buffer_load_dwordx4 v[196:199], v221, s[24:27], s21 offen
    s_add_u32 s62, s21, 7168
    buffer_load_dwordx4 v[216:219], v221, s[24:27], s62 offen
    s_add_u32 s21, s21, 14336
    s_cmp_eq_u32 s21, 229376
    s_cselect_b32 s21, 0, s21
    v_mfma_f32_32x32x16_bf16 v[48:63], v[68:71], v[164:167], v[48:63]
    s_waitcnt vmcnt(11) lgkmcnt(2)
    v_mfma_f32_32x32x16_bf16 v[0:15], v[72:75], v[92:95], v[0:15]
    s_waitcnt lgkmcnt(0)
    v_mfma_f32_32x32x16_bf16 v[32:47], v[76:79], v[92:95], v[32:47]
    ds_read_b64_tr_b16 v[64:65], v250 offset:16384
    ds_read_b64_tr_b16 v[66:67], v250 offset:16896
    ds_read_b64_tr_b16 v[68:69], v251 offset:16384
    ds_read_b64_tr_b16 v[70:71], v251 offset:16896
    s_waitcnt vmcnt(10)
    v_mfma_f32_32x32x16_bf16 v[16:31], v[72:75], v[176:179], v[16:31]
    buffer_load_dwordx4 v[120:123], v241, s[16:19], s8 offen sc1
    buffer_load_dwordx4 v[200:203], v242, s[16:19], s8 offen sc1
    s_add_u32 s8, s8, 1024
    s_cmp_eq_u32 s8, s9
    s_cselect_b32 s8, s10, s8
    v_mfma_f32_32x32x16_bf16 v[48:63], v[76:79], v[176:179], v[48:63]
    s_waitcnt vmcnt(9) lgkmcnt(2)
    v_mfma_f32_32x32x16_bf16 v[0:15], v[64:67], v[104:107], v[0:15]
    s_waitcnt lgkmcnt(0)
    v_mfma_f32_32x32x16_bf16 v[32:47], v[68:71], v[104:107], v[32:47]
    ds_read_b64_tr_b16 v[72:73], v250 offset:18432
    ds_read_b64_tr_b16 v[74:75], v250 offset:18944
    ds_read_b64_tr_b16 v[76:77], v251 offset:18432
    ds_read_b64_tr_b16 v[78:79], v251 offset:18944
    s_waitcnt vmcnt(8)
    v_mfma_f32_32x32x16_bf16 v[16:31], v[64:67], v[184:187], v[16:31]
    buffer_load_dwordx4 v[204:207], v221, s[24:27], s21 offen
    s_add_u32 s62, s21, 7168
    buffer_load_dwordx4 v[124:127], v221, s[24:27], s62 offen
    s_add_u32 s21, s21, 14336
    s_cmp_eq_u32 s21, 229376
    s_cselect_b32 s21, 0, s21
    v_mfma_f32_32x32x16_bf16 v[48:63], v[68:71], v[184:187], v[48:63]
    buffer_load_dwordx4 v[80:83], v241, s[16:19], s8 offen sc1
    buffer_load_dwordx4 v[208:211], v242, s[16:19], s8 offen sc1
    s_add_u32 s8, s8, 1024
    s_cmp_eq_u32 s8, s9
    s_cselect_b32 s8, s10, s8
    ds_write_b128 v247, v[180:183] offset:4096
    ds_write_b128 v247, v[96:99] offset:5120
    s_waitcnt vmcnt(9) lgkmcnt(4)
    v_mfma_f32_32x32x16_bf16 v[0:15], v[72:75], v[100:103], v[0:15]
    s_waitcnt lgkmcnt(2)
    v_mfma_f32_32x32x16_bf16 v[32:47], v[76:79], v[100:103], v[32:47]
    ds_read_b64_tr_b16 v[64:65], v250 offset:0
    ds_read_b64_tr_b16 v[66:67], v250 offset:512
    ds_read_b64_tr_b16 v[68:69], v251 offset:0
    ds_read_b64_tr_b16 v[70:71], v251 offset:512
    s_waitcnt vmcnt(8)
    v_mfma_f32_32x32x16_bf16 v[16:31], v[72:75], v[192:195], v[16:31]
    buffer_load_dwordx4 v[112:115], v221, s[24:27], s21 offen
    s_add_u32 s62, s21, 7168
    buffer_load_dwordx4 v[84:87], v221, s[24:27], s62 offen
    s_add_u32 s21, s21, 14336
    s_cmp_eq_u32 s21, 229376
    s_cselect_b32 s21, 0, s21
    v_mfma_f32_32x32x16_bf16 v[48:63], v[76:79], v[192:195], v[48:63]
    buffer_load_dwordx4 v[128:131], v241, s[16:19], s8 offen sc1
    buffer_load_dwordx4 v[116:119], v242, s[16:19], s8 offen sc1
    s_add_u32 s8, s8, 1024
    s_cmp_eq_u32 s8, s9
    s_cselect_b32 s8, s10, s8
    ds_write_b128 v247, v[188:191] offset:6144
    ds_write_b128 v247, v[108:111] offset:7168
    s_waitcnt vmcnt(9) lgkmcnt(4)
    v_mfma_f32_32x32x16_bf16 v[0:15], v[64:67], v[120:123], v[0:15]
    s_waitcnt lgkmcnt(2)
    v_mfma_f32_32x32x16_bf16 v[32:47], v[68:71], v[120:123], v[32:47]
    ds_read_b64_tr_b16 v[72:73], v250 offset:2048
    ds_read_b64_tr_b16 v[74:75], v250 offset:2560
    ds_read_b64_tr_b16 v[76:77], v251 offset:2048
    ds_read_b64_tr_b16 v[78:79], v251 offset:2560
    s_waitcnt vmcnt(8)
    v_mfma_f32_32x32x16_bf16 v[16:31], v[64:67], v[200:203], v[16:31]
    buffer_load_dwordx4 v[212:215], v241, s[16:19], s8 offen sc1
    buffer_load_dwordx4 v[132:135], v242, s[16:19], s8 offen sc1
    s_add_u32 s8, s8, 1024
    s_cmp_eq_u32 s8, s9
    s_cselect_b32 s8, s10, s8
    v_mfma_f32_32x32x16_bf16 v[48:63], v[68:71], v[200:203], v[48:63]
    buffer_load_dwordx4 v[88:91], v241, s[16:19], s8 offen sc1
    buffer_load_dwordx4 v[160:163], v242, s[16:19], s8 offen sc1
    s_add_u32 s8, s8, 1024
    s_cmp_eq_u32 s8, s9
    s_cselect_b32 s8, s10, s8
    ds_write_b128 v247, v[196:199] offset:8192
    ds_write_b128 v247, v[216:219] offset:9216
    s_and_b32 exec_lo, s98, 0
    s_and_b32 exec_hi, s99, 65283
    s_or_b32 exec_lo, exec_lo, 65536
    buffer_load_dwordx2 v[230:231], v238, s[16:19], 0 offen sc1
    s_mov_b64 exec, -1
    s_waitcnt vmcnt(10) lgkmcnt(4)
    v_mfma_f32_32x32x16_bf16 v[0:15], v[72:75], v[80:83], v[0:15]
    s_waitcnt lgkmcnt(2)
    v_mfma_f32_32x32x16_bf16 v[32:47], v[76:79], v[80:83], v[32:47]
    ds_read_b64_tr_b16 v[64:65], v250 offset:4096
    ds_read_b64_tr_b16 v[66:67], v250 offset:4608
    ds_read_b64_tr_b16 v[68:69], v251 offset:4096
    ds_read_b64_tr_b16 v[70:71], v251 offset:4608
    s_waitcnt vmcnt(9)
    v_mfma_f32_32x32x16_bf16 v[16:31], v[72:75], v[208:211], v[16:31]
    buffer_load_dwordx4 v[168:171], v241, s[16:19], s8 offen sc1
    buffer_load_dwordx4 v[172:175], v242, s[16:19], s8 offen sc1
    s_add_u32 s8, s8, 1024
    s_cmp_eq_u32 s8, s9
    s_cselect_b32 s8, s10, s8
    v_mfma_f32_32x32x16_bf16 v[48:63], v[76:79], v[208:211], v[48:63]
    ds_write_b128 v247, v[204:207] offset:10240
    ds_write_b128 v247, v[124:127] offset:11264
    s_waitcnt vmcnt(8) lgkmcnt(4)
    v_mfma_f32_32x32x16_bf16 v[0:15], v[64:67], v[128:131], v[0:15]
    s_waitcnt lgkmcnt(2)
    v_mfma_f32_32x32x16_bf16 v[32:47], v[68:71], v[128:131], v[32:47]
    ds_read_b64_tr_b16 v[72:73], v250 offset:6144
    ds_read_b64_tr_b16 v[74:75], v250 offset:6656
    ds_read_b64_tr_b16 v[76:77], v251 offset:6144
    ds_read_b64_tr_b16 v[78:79], v251 offset:6656
    s_waitcnt vmcnt(7)
    v_mfma_f32_32x32x16_bf16 v[16:31], v[64:67], v[116:119], v[16:31]
    buffer_load_dwordx4 v[164:167], v223, s[28:31], s22 offen
    s_add_u32 s62, s22, 7168
    buffer_load_dwordx4 v[92:95], v223, s[28:31], s62 offen
    s_add_u32 s22, s22, 14336
    v_mfma_f32_32x32x16_bf16 v[48:63], v[68:71], v[116:119], v[48:63]
    buffer_load_dwordx4 v[176:179], v241, s[16:19], s8 offen sc1
    buffer_load_dwordx4 v[104:107], v242, s[16:19], s8 offen sc1
    s_add_u32 s8, s8, 1024
    s_cmp_eq_u32 s8, s9
    s_cselect_b32 s8, s10, s8
    ds_write_b128 v247, v[112:115] offset:12288
    ds_write_b128 v247, v[84:87] offset:13312
    s_waitcnt vmcnt(10) lgkmcnt(4)
    v_mfma_f32_32x32x16_bf16 v[0:15], v[72:75], v[212:215], v[0:15]
    s_waitcnt lgkmcnt(2)
    v_mfma_f32_32x32x16_bf16 v[32:47], v[76:79], v[212:215], v[32:47]
    ds_read_b64_tr_b16 v[64:65], v250 offset:8192
    ds_read_b64_tr_b16 v[66:67], v250 offset:8704
    ds_read_b64_tr_b16 v[68:69], v251 offset:8192
    ds_read_b64_tr_b16 v[70:71], v251 offset:8704
    s_waitcnt vmcnt(9)
    v_mfma_f32_32x32x16_bf16 v[16:31], v[72:75], v[132:135], v[16:31]
    buffer_load_dwordx4 v[184:187], v223, s[28:31], s22 offen
    s_add_u32 s62, s22, 7168
    buffer_load_dwordx4 v[100:103], v223, s[28:31], s62 offen
    s_add_u32 s22, s22, 10752
    s_cmp_eq_u32 s22, 100352
    s_cselect_b32 s22, 0, s22
    v_mfma_f32_32x32x16_bf16 v[48:63], v[76:79], v[132:135], v[48:63]
    ds_write_b128 v247, v[136:139] offset:14336
    ds_write_b128 v247, v[140:143] offset:15360
    s_waitcnt vmcnt(8)
    v_cmp_ne_u64 vcc, s[60:61], v[230:231]
    s_nop 0
    s_and_b64 s[98:99], s[98:99], vcc
    s_and_b32 s62, s99, 3
    s_cbranch_scc1 SLOW_23
RET_24:
    s_mul_i32 s10, s40, 1024
    s_add_u32 s10, s10, s48
    s_add_u32 s10, s10, 110592
    s_add_u32 s9, s10, 1024
    s_mov_b32 s8, s10
    buffer_load_dwordx4 v[192:195], v241, s[16:19], s8 offen sc1
    buffer_load_dwordx4 v[180:183], v242, s[16:19], s8 offen sc1
    s_add_u32 s8, s8, 1024
    s_cmp_eq_u32 s8, s9
    s_cselect_b32 s8, s10, s8
    buffer_load_dwordx4 v[96:99], v223, s[28:31], s22 offen
    s_add_u32 s62, s22, 7168
    buffer_load_dwordx4 v[120:123], v223, s[28:31], s62 offen
    s_add_u32 s22, s22, 14336
    s_waitcnt lgkmcnt(4)
    v_mfma_f32_32x32x16_bf16 v[0:15], v[64:67], v[88:91], v[0:15]
    s_waitcnt lgkmcnt(2)
    v_mfma_f32_32x32x16_bf16 v[32:47], v[68:71], v[88:91], v[32:47]
    ds_read_b64_tr_b16 v[72:73], v250 offset:10240
    ds_read_b64_tr_b16 v[74:75], v250 offset:10752
    ds_read_b64_tr_b16 v[76:77], v251 offset:10240
    ds_read_b64_tr_b16 v[78:79], v251 offset:10752
    v_mfma_f32_32x32x16_bf16 v[16:31], v[64:67], v[160:163], v[16:31]
    v_mfma_f32_32x32x16_bf16 v[48:63], v[68:71], v[160:163], v[48:63]
    ds_write_b128 v247, v[144:147] offset:16384
    ds_write_b128 v247, v[148:151] offset:17408
    v_cmp_ne_u64 vcc, s[60:61], v[230:231]
    s_nop 0
    s_and_b64 s[98:99], s[98:99], vcc
    s_and_b32 s62, s99, 65280
    s_cbranch_scc1 SLOW_25
RET_26:
    s_mul_i32 s14, s40, 8192
    s_add_u32 s14, s14, s49
    s_add_u32 s13, s14, 8192
    s_bfe_u32 s12, s23, 524304
    s_lshl_b32 s12, s12, 11
    s_add_u32 s12, s12, s14
    buffer_load_dwordx4 v[200:203], v243, s[16:19], s12 offen sc1
    buffer_load_dwordx4 v[188:191], v239, s[16:19], s12 offen sc1
    s_add_u32 s12, s12, 1024
    s_cmp_eq_u32 s12, s13
    s_cselect_b32 s12, s14, s12
    buffer_load_dwordx4 v[108:111], v243, s[16:19], s12 offen sc1
    buffer_load_dwordx4 v[80:83], v239, s[16:19], s12 offen sc1
    s_add_u32 s12, s12, 1024
    s_cmp_eq_u32 s12, s13
    s_cselect_b32 s12, s14, s12
    buffer_load_dwordx4 v[208:211], v243, s[16:19], s12 offen sc1
    buffer_load_dwordx4 v[196:199], v239, s[16:19], s12 offen sc1
    s_add_u32 s12, s12, 1024
    s_cmp_eq_u32 s12, s13
    s_cselect_b32 s12, s14, s12
    buffer_load_dwordx4 v[216:219], v243, s[16:19], s12 offen sc1
    buffer_load_dwordx4 v[128:131], v239, s[16:19], s12 offen sc1
    s_add_u32 s12, s12, 1024
    s_cmp_eq_u32 s12, s13
    s_cselect_b32 s12, s14, s12
    buffer_load_dwordx4 v[116:119], v243, s[16:19], s12 offen sc1
    buffer_load_dwordx4 v[204:207], v239, s[16:19], s12 offen sc1
    s_add_u32 s12, s12, 1024
    s_cmp_eq_u32 s12, s13
    s_cselect_b32 s12, s14, s12
    buffer_load_dwordx4 v[124:127], v243, s[16:19], s12 offen sc1
    buffer_load_dwordx4 v[212:215], v239, s[16:19], s12 offen sc1
    s_add_u32 s12, s12, 1024
    s_cmp_eq_u32 s12, s13
    s_cselect_b32 s12, s14, s12
    s_waitcnt vmcnt(23) lgkmcnt(4)
    v_mfma_f32_32x32x16_bf16 v[0:15], v[72:75], v[168:171], v[0:15]
    s_waitcnt lgkmcnt(2)
    v_mfma_f32_32x32x16_bf16 v[32:47], v[76:79], v[168:171], v[32:47]
    ds_read_b64_tr_b16 v[64:65], v250 offset:12288
    ds_read_b64_tr_b16 v[66:67], v250 offset:12800
    ds_read_b64_tr_b16 v[68:69], v251 offset:12288
    ds_read_b64_tr_b16 v[70:71], v251 offset:12800
    s_waitcnt vmcnt(22)
    v_mfma_f32_32x32x16_bf16 v[16:31], v[72:75], v[172:175], v[16:31]
    v_mfma_f32_32x32x16_bf16 v[48:63], v[76:79], v[172:175], v[48:63]
    ds_write_b128 v247, v[152:155] offset:18432
    ds_write_b128 v247, v[156:159] offset:19456
    s_waitcnt vmcnt(19) lgkmcnt(4)
    v_mfma_f32_32x32x16_bf16 v[0:15], v[64:67], v[176:179], v[0:15]
    s_waitcnt lgkmcnt(2)
    v_mfma_f32_32x32x16_bf16 v[32:47], v[68:71], v[176:179], v[32:47]
    ds_read_b64_tr_b16 v[72:73], v250 offset:14336
    ds_read_b64_tr_b16 v[74:75], v250 offset:14848
    ds_read_b64_tr_b16 v[76:77], v251 offset:14336
    ds_read_b64_tr_b16 v[78:79], v251 offset:14848
    s_waitcnt vmcnt(18)
    v_mfma_f32_32x32x16_bf16 v[16:31], v[64:67], v[104:107], v[16:31]
    v_mfma_f32_32x32x16_bf16 v[48:63], v[68:71], v[104:107], v[48:63]
    ds_write_b128 v247, v[164:167] offset:0
    ds_write_b128 v247, v[92:95] offset:1024
    s_waitcnt vmcnt(15) lgkmcnt(4)
    v_mfma_f32_32x32x16_bf16 v[0:15], v[72:75], v[192:195], v[0:15]
    s_waitcnt lgkmcnt(2)
    v_mfma_f32_32x32x16_bf16 v[32:47], v[76:79], v[192:195], v[32:47]
    ds_read_b64_tr_b16 v[64:65], v250 offset:16384
    ds_read_b64_tr_b16 v[66:67], v250 offset:16896
    ds_read_b64_tr_b16 v[68:69], v251 offset:16384
    ds_read_b64_tr_b16 v[70:71], v251 offset:16896
    s_waitcnt vmcnt(14)
    v_mfma_f32_32x32x16_bf16 v[16:31], v[72:75], v[180:183], v[16:31]
    v_mfma_f32_32x32x16_bf16 v[48:63], v[76:79], v[180:183], v[48:63]
    ds_write_b128 v247, v[184:187] offset:2048
    ds_write_b128 v247, v[100:103] offset:3072
    s_waitcnt vmcnt(11) lgkmcnt(4)
    v_mfma_f32_32x32x16_bf16 v[0:15], v[64:67], v[200:203], v[0:15]
    s_waitcnt lgkmcnt(2)
    v_mfma_f32_32x32x16_bf16 v[32:47], v[68:71], v[200:203], v[32:47]
    ds_read_b64_tr_b16 v[72:73], v250 offset:18432
    ds_read_b64_tr_b16 v[74:75], v250 offset:18944
    ds_read_b64_tr_b16 v[76:77], v251 offset:18432
    ds_read_b64_tr_b16 v[78:79], v251 offset:18944
    s_waitcnt vmcnt(10)
    v_mfma_f32_32x32x16_bf16 v[16:31], v[64:67], v[188:191], v[16:31]
    buffer_load_dwordx4 v[132:135], v223, s[28:31], s22 offen
    s_add_u32 s62, s22, 7168
    buffer_load_dwordx4 v[112:115], v223, s[28:31], s62 offen
    s_add_u32 s22, s22, 10752
    s_cmp_eq_u32 s22, 100352
    s_cselect_b32 s22, 0, s22
    v_mfma_f32_32x32x16_bf16 v[48:63], v[68:71], v[188:191], v[48:63]
    ds_write_b128 v247, v[96:99] offset:4096
    ds_write_b128 v247, v[120:123] offset:5120
    s_waitcnt vmcnt(11) lgkmcnt(4)
    v_mfma_f32_32x32x16_bf16 v[0:15], v[72:75], v[108:111], v[0:15]
    s_waitcnt lgkmcnt(2)
    v_mfma_f32_32x32x16_bf16 v[32:47], v[76:79], v[108:111], v[32:47]
    ds_read_b64_tr_b16 v[64:65], v250 offset:0
    ds_read_b64_tr_b16 v[66:67], v250 offset:512
    ds_read_b64_tr_b16 v[68:69], v251 offset:0
    ds_read_b64_tr_b16 v[70:71], v251 offset:512
    s_waitcnt vmcnt(10)
    v_mfma_f32_32x32x16_bf16 v[16:31], v[72:75], v[80:83], v[16:31]
    buffer_load_dwordx4 v[84:87], v223, s[28:31], s22 offen
    s_add_u32 s62, s22, 7168
    buffer_load_dwordx4 v[88:91], v223, s[28:31], s62 offen
    s_add_u32 s22, s22, 14336
    v_mfma_f32_32x32x16_bf16 v[48:63], v[76:79], v[80:83], v[48:63]
    s_waitcnt vmcnt(11) lgkmcnt(2)
    v_mfma_f32_32x32x16_bf16 v[0:15], v[64:67], v[208:211], v[0:15]
    s_waitcnt lgkmcnt(0)
    v_mfma_f32_32x32x16_bf16 v[32:47], v[68:71], v[208:211], v[32:47]
    ds_read_b64_tr_b16 v[72:73], v250 offset:2048
    ds_read_b64_tr_b16 v[74:75], v250 offset:2560
    ds_read_b64_tr_b16 v[76:77], v251 offset:2048
    ds_read_b64_tr_b16 v[78:79], v251 offset:2560
    s_waitcnt vmcnt(10)
    v_mfma_f32_32x32x16_bf16 v[16:31], v[64:67], v[196:199], v[16:31]
    buffer_load_dwordx4 v[160:163], v223, s[28:31], s22 offen
    s_add_u32 s62, s22, 7168
    buffer_load_dwordx4 v[136:139], v223, s[28:31], s62 offen
    s_add_u32 s22, s22, 10752
    s_cmp_eq_u32 s22, 100352
    s_cselect_b32 s22, 0, s22
    v_mfma_f32_32x32x16_bf16 v[48:63], v[68:71], v[196:199], v[48:63]
    s_waitcnt vmcnt(5)
    ds_write_b128 v247, v[132:135] offset:6144
    s_waitcnt vmcnt(4)
    ds_write_b128 v247, v[112:115] offset:7168
    buffer_load_dwordx4 v[140:143], v243, s[16:19], s12 offen sc1
    buffer_load_dwordx4 v[168:171], v239, s[16:19], s12 offen sc1
    s_add_u32 s12, s12, 1024
    s_cmp_eq_u32 s12, s13
    s_cselect_b32 s12, s14, s12
    s_waitcnt lgkmcnt(4)
    v_mfma_f32_32x32x16_bf16 v[0:15], v[72:75], v[216:219], v[0:15]
    s_waitcnt lgkmcnt(2)
    v_mfma_f32_32x32x16_bf16 v[32:47], v[76:79], v[216:219], v[32:47]
    ds_read_b64_tr_b16 v[64:65], v250 offset:4096
    ds_read_b64_tr_b16 v[66:67], v250 offset:4608
    ds_read_b64_tr_b16 v[68:69], v251 offset:4096
    ds_read_b64_tr_b16 v[70:71], v251 offset:4608
    v_mfma_f32_32x32x16_bf16 v[16:31], v[72:75], v[128:131], v[16:31]
    buffer_load_dwordx4 v[172:175], v243, s[16:19], s12 offen sc1
    buffer_load_dwordx4 v[144:147], v239, s[16:19], s12 offen sc1
    s_add_u32 s12, s12, 1024
    s_cmp_eq_u32 s12, s13
    s_cselect_b32 s12, s14, s12
    v_mfma_f32_32x32x16_bf16 v[48:63], v[76:79], v[128:131], v[48:63]
    s_waitcnt vmcnt(7)
    ds_write_b128 v247, v[84:87] offset:8192
    s_waitcnt vmcnt(6)
    ds_write_b128 v247, v[88:91] offset:9216
    s_waitcnt lgkmcnt(4)
    v_mfma_f32_32x32x16_bf16 v[0:15], v[64:67], v[116:119], v[0:15]
    s_waitcnt lgkmcnt(2)
    v_mfma_f32_32x32x16_bf16 v[32:47], v[68:71], v[116:119], v[32:47]
    ds_read_b64_tr_b16 v[72:73], v250 offset:6144
    ds_read_b64_tr_b16 v[74:75], v250 offset:6656
    ds_read_b64_tr_b16 v[76:77], v251 offset:6144
    ds_read_b64_tr_b16 v[78:79], v251 offset:6656
    v_mfma_f32_32x32x16_bf16 v[16:31], v[64:67], v[204:207], v[16:31]
    v_mfma_f32_32x32x16_bf16 v[48:63], v[68:71], v[204:207], v[48:63]
    s_waitcnt vmcnt(5)
    ds_write_b128 v247, v[160:163] offset:10240
    s_waitcnt vmcnt(4)
    ds_write_b128 v247, v[136:139] offset:11264
    s_waitcnt lgkmcnt(4)
    v_mfma_f32_32x32x16_bf16 v[0:15], v[72:75], v[124:127], v[0:15]
    s_waitcnt lgkmcnt(2)
    v_mfma_f32_32x32x16_bf16 v[32:47], v[76:79], v[124:127], v[32:47]
    ds_read_b64_tr_b16 v[64:65], v250 offset:8192
    ds_read_b64_tr_b16 v[66:67], v250 offset:8704
    ds_read_b64_tr_b16 v[68:69], v251 offset:8192
    ds_read_b64_tr_b16 v[70:71], v251 offset:8704
    v_mfma_f32_32x32x16_bf16 v[16:31], v[72:75], v[212:215], v[16:31]
    v_mfma_f32_32x32x16_bf16 v[48:63], v[76:79], v[212:215], v[48:63]
    s_waitcnt vmcnt(3) lgkmcnt(2)
    v_mfma_f32_32x32x16_bf16 v[0:15], v[64:67], v[140:143], v[0:15]
    s_waitcnt lgkmcnt(0)
    v_mfma_f32_32x32x16_bf16 v[32:47], v[68:71], v[140:143], v[32:47]
    ds_read_b64_tr_b16 v[72:73], v250 offset:10240
    ds_read_b64_tr_b16 v[74:75], v250 offset:10752
    ds_read_b64_tr_b16 v[76:77], v251 offset:10240
    ds_read_b64_tr_b16 v[78:79], v251 offset:10752
    s_waitcnt vmcnt(2)
    v_mfma_f32_32x32x16_bf16 v[16:31], v[64:67], v[168:171], v[16:31]
    v_mfma_f32_32x32x16_bf16 v[48:63], v[68:71], v[168:171], v[48:63]
    s_waitcnt vmcnt(1) lgkmcnt(2)
    v_mfma_f32_32x32x16_bf16 v[0:15], v[72:75], v[172:175], v[0:15]
    s_waitcnt lgkmcnt(0)
    v_mfma_f32_32x32x16_bf16 v[32:47], v[76:79], v[172:175], v[32:47]
    s_waitcnt vmcnt(0)
    v_mfma_f32_32x32x16_bf16 v[16:31], v[72:75], v[144:147], v[16:31]
    v_mfma_f32_32x32x16_bf16 v[48:63], v[76:79], v[144:147], v[48:63]
    s_nop 8
    ds_write_b128 v247, v[32:35] offset:4096
    ds_write_b128 v247, v[36:39] offset:5120
    ds_write_b128 v247, v[40:43] offset:6144
    ds_write_b128 v247, v[44:47] offset:7168
    ds_write_b128 v247, v[16:19] offset:0
    ds_write_b128 v247, v[20:23] offset:1024
    ds_write_b128 v247, v[24:27] offset:2048
    ds_write_b128 v247, v[28:31] offset:3072
    ds_write_b128 v247, v[48:51] offset:8192
    ds_write_b128 v247, v[52:55] offset:9216
    ds_write_b128 v247, v[56:59] offset:10240
    ds_write_b128 v247, v[60:63] offset:11264
    s_waitcnt lgkmcnt(0)
    s_barrier
    ds_read_b128 v[16:19], v224 offset:0
    ds_read_b128 v[20:23], v224 offset:1024
    ds_read_b128 v[24:27], v224 offset:2048
    ds_read_b128 v[28:31], v224 offset:3072
    ds_read_b128 v[32:35], v225 offset:0
    ds_read_b128 v[36:39], v225 offset:1024
    ds_read_b128 v[40:43], v225 offset:2048
    ds_read_b128 v[44:47], v225 offset:3072
    ds_read_b128 v[48:51], v226 offset:0
    ds_read_b128 v[52:55], v226 offset:1024
    ds_read_b128 v[56:59], v226 offset:2048
    ds_read_b128 v[60:63], v226 offset:3072
    s_waitcnt lgkmcnt(11)
    v_add_f32 v0, v0, v16
    v_add_f32 v1, v1, v17
    v_add_f32 v2, v2, v18
    v_add_f32 v3, v3, v19
    s_waitcnt lgkmcnt(10)
    v_add_f32 v4, v4, v20
    v_add_f32 v5, v5, v21
    v_add_f32 v6, v6, v22
    v_add_f32 v7, v7, v23
    s_waitcnt lgkmcnt(9)
    v_add_f32 v8, v8, v24
    v_add_f32 v9, v9, v25
    v_add_f32 v10, v10, v26
    v_add_f32 v11, v11, v27
    s_waitcnt lgkmcnt(8)
    v_add_f32 v12, v12, v28
    v_add_f32 v13, v13, v29
    v_add_f32 v14, v14, v30
    v_add_f32 v15, v15, v31
    s_waitcnt lgkmcnt(3)
    v_add_f32 v32, v32, v48
    v_add_f32 v33, v33, v49
    v_add_f32 v34, v34, v50
    v_add_f32 v35, v35, v51
    s_waitcnt lgkmcnt(2)
    v_add_f32 v36, v36, v52
    v_add_f32 v37, v37, v53
    v_add_f32 v38, v38, v54
    v_add_f32 v39, v39, v55
    v_add_f32 v0, v0, v32
    v_add_f32 v1, v1, v33
    v_add_f32 v2, v2, v34
    v_add_f32 v3, v3, v35
    v_add_f32 v4, v4, v36
    v_add_f32 v5, v5, v37
    v_add_f32 v6, v6, v38
    v_add_f32 v7, v7, v39
    v_cvt_pk_bf16_f32 v16, v0, v1
    v_cvt_pk_bf16_f32 v17, v2, v3
    v_cvt_pk_bf16_f32 v18, v4, v5
    v_cvt_pk_bf16_f32 v19, v6, v7
    buffer_store_dwordx4 v[16:19], v252, s[32:35], 0 offen offset:0
    s_waitcnt lgkmcnt(1)
    v_add_f32 v40, v40, v56
    v_add_f32 v41, v41, v57
    v_add_f32 v42, v42, v58
    v_add_f32 v43, v43, v59
    s_waitcnt lgkmcnt(0)
    v_add_f32 v44, v44, v60
    v_add_f32 v45, v45, v61
    v_add_f32 v46, v46, v62
    v_add_f32 v47, v47, v63
    v_add_f32 v8, v8, v40
    v_add_f32 v9, v9, v41
    v_add_f32 v10, v10, v42
    v_add_f32 v11, v11, v43
    v_add_f32 v12, v12, v44
    v_add_f32 v13, v13, v45
    v_add_f32 v14, v14, v46
    v_add_f32 v15, v15, v47
    v_cvt_pk_bf16_f32 v20, v8, v9
    v_cvt_pk_bf16_f32 v21, v10, v11
    v_cvt_pk_bf16_f32 v22, v12, v13
    v_cvt_pk_bf16_f32 v23, v14, v15
    buffer_store_dwordx4 v[20:23], v252, s[32:35], 0 offen offset:32
L_end:
    s_endpgm
L_pf:
    s_branch L_end
SLOW_1:
    s_mov_b32 s63, 0
ZS_27:
    s_sleep 2
    ds_read_b128 v[76:79], v255 offset:448
    s_add_u32 s63, s63, 1
    s_cmp_lt_u32 s63, 131072
    s_waitcnt lgkmcnt(0)
    v_or3_b32 v76, v76, v77, v78
    v_or_b32 v76, v76, v79
    v_cmp_ne_u32 vcc, 0, v76
    s_cbranch_scc0 ZD_28
    s_nop 3
    s_cbranch_vccnz ZS_27
ZD_28:
    s_branch RET_2
SLOW_3:
    s_mov_b32 s63, 0
ZS_29:
    s_sleep 2
    ds_read_b128 v[76:79], v255 offset:464
    s_add_u32 s63, s63, 1
    s_cmp_lt_u32 s63, 131072
    s_waitcnt lgkmcnt(0)
    v_or3_b32 v76, v76, v77, v78
    v_or_b32 v76, v76, v79
    v_cmp_ne_u32 vcc, 0, v76
    s_cbranch_scc0 ZD_30
    s_nop 3
    s_cbranch_vccnz ZS_29
ZD_30:
    s_branch RET_4
SLOW_5:
    s_mov_b32 s63, 0
ZS_31:
    s_sleep 2
    ds_read_b128 v[76:79], v255 offset:480
    s_add_u32 s63, s63, 1
    s_cmp_lt_u32 s63, 131072
    s_waitcnt lgkmcnt(0)
    v_or3_b32 v76, v76, v77, v78
    v_or_b32 v76, v76, v79
    v_cmp_ne_u32 vcc, 0, v76
    s_cbranch_scc0 ZD_32
    s_nop 3
    s_cbranch_vccnz ZS_31
ZD_32:
    s_branch RET_6
SLOW_7:
    s_mov_b32 s63, 0
ZS_33:
    s_sleep 2
    ds_read_b128 v[76:79], v255 offset:496
    s_add_u32 s63, s63, 1
    s_cmp_lt_u32 s63, 131072
    s_waitcnt lgkmcnt(0)
    v_or3_b32 v76, v76, v77, v78
    v_or_b32 v76, v76, v79
    v_cmp_ne_u32 vcc, 0, v76
    s_cbranch_scc0 ZD_34
    s_nop 3
    s_cbranch_vccnz ZS_33
ZD_34:
    s_branch RET_8
SLOW_9:
    s_mov_b32 s63, 0
ZS_35:
    s_sleep 2
    ds_read_b128 v[76:79], v255 offset:512
    s_add_u32 s63, s63, 1
    s_cmp_lt_u32 s63, 131072
    s_waitcnt lgkmcnt(0)
    v_or3_b32 v76, v76, v77, v78
    v_or_b32 v76, v76, v79
    v_cmp_ne_u32 vcc, 0, v76
    s_cbranch_scc0 ZD_36
    s_nop 3
    s_cbranch_vccnz ZS_35
ZD_36:
    s_branch RET_10
SLOW_11:
    ds_read_b128 v[76:79], v255 offset:560
    s_waitcnt lgkmcnt(0)
    v_or3_b32 v76, v76, v77, v78
    v_or_b32 v76, v76, v79
    v_cmp_ne_u32 vcc, 0, v76
    s_nop 4
    s_cbranch_vccnz SLOW_37
RET_38:
    s_waitcnt vmcnt(6)
    s_add_u32 m0, s50, 0
    s_nop 0
    buffer_load_dwordx4 v248, s[8:11], s54 offen lds
    s_add_u32 s54, s54, 114688
    s_waitcnt vmcnt(6)
    s_add_u32 m0, s50, 4096
    s_nop 0
    buffer_load_dwordx4 v248, s[8:11], s54 offen lds
    s_add_u32 s54, s54, 114688
    s_cmp_eq_u32 s54, 1605632
    s_cselect_b32 s54, 0, s54
    s_add_u32 m0, s46, 224
    s_mov_b64 exec, 1
    buffer_load_dword v255, s[36:39], 0 offen lds
    s_mov_b64 exec, -1
    s_waitcnt vmcnt(6)
    s_add_u32 m0, s50, 8192
    s_nop 0
    buffer_load_dwordx4 v248, s[8:11], s54 offen lds
    s_add_u32 s54, s54, 114688
    s_waitcnt vmcnt(6)
    s_add_u32 m0, s50, 12288
    s_nop 0
    buffer_load_dwordx4 v248, s[8:11], s54 offen lds
    s_add_u32 s54, s54, 114688
    s_cmp_eq_u32 s54, 1605632
    s_cselect_b32 s54, 0, s54
    s_add_u32 m0, s46, 240
    s_mov_b64 exec, 1
    buffer_load_dword v255, s[36:39], 0 offen lds
    s_mov_b64 exec, -1
    s_waitcnt vmcnt(6)
    s_add_u32 m0, s50, 16384
    s_nop 0
    buffer_load_dwordx4 v248, s[8:11], s54 offen lds
    s_add_u32 s54, s54, 114688
    s_waitcnt vmcnt(6)
    s_add_u32 m0, s50, 20480
    s_nop 0
    buffer_load_dwordx4 v248, s[8:11], s54 offen lds
    s_add_u32 s54, s54, 114688
    s_cmp_eq_u32 s54, 1605632
    s_cselect_b32 s54, 0, s54
    s_add_u32 m0, s46, 256
    s_mov_b64 exec, 1
    buffer_load_dword v255, s[36:39], 0 offen lds
    s_mov_b64 exec, -1
    s_waitcnt vmcnt(6)
    s_add_u32 m0, s50, 24576
    s_nop 0
    buffer_load_dwordx4 v248, s[8:11], s54 offen lds
    s_add_u32 s54, s54, 114688
    s_waitcnt vmcnt(6)
    s_add_u32 m0, s50, 28672
    s_nop 0
    buffer_load_dwordx4 v248, s[8:11], s54 offen lds
    s_add_u32 s54, s54, 114688
    s_cmp_eq_u32 s54, 1605632
    s_cselect_b32 s54, 0, s54
    s_add_u32 m0, s46, 272
    s_mov_b64 exec, 1
    buffer_load_dword v255, s[36:39], 0 offen lds
    s_mov_b64 exec, -1
    s_waitcnt vmcnt(6)
    s_add_u32 m0, s50, 32768
    s_nop 0
    buffer_load_dwordx4 v248, s[8:11], s54 offen lds
    s_add_u32 s54, s54, 114688
    s_waitcnt vmcnt(6)
    s_add_u32 m0, s50, 36864
    s_nop 0
    buffer_load_dwordx4 v248, s[8:11], s54 offen lds
    s_add_u32 s54, s54, 114688
    s_cmp_eq_u32 s54, 1605632
    s_cselect_b32 s54, 0, s54
    s_add_u32 m0, s46, 288
    s_mov_b64 exec, 1
    buffer_load_dword v255, s[36:39], 0 offen lds
    s_mov_b64 exec, -1
    s_waitcnt vmcnt(6)
    s_add_u32 m0, s50, 40960
    s_nop 0
    buffer_load_dwordx4 v248, s[8:11], s54 offen lds
    s_add_u32 s54, s54, 114688
    s_waitcnt vmcnt(6)
    s_add_u32 m0, s50, 45056
    s_nop 0
    buffer_load_dwordx4 v248, s[8:11], s54 offen lds
    s_add_u32 s54, s54, 114688
    s_cmp_eq_u32 s54, 1605632
    s_cselect_b32 s54, 0, s54
    s_add_u32 m0, s46, 304
    s_mov_b64 exec, 1
    buffer_load_dword v255, s[36:39], 0 offen lds
    s_mov_b64 exec, -1
    s_waitcnt vmcnt(6)
    s_add_u32 m0, s50, 49152
    s_nop 0
    buffer_load_dwordx4 v248, s[8:11], s54 offen lds
    s_add_u32 s54, s54, 114688
    s_waitcnt vmcnt(6)
    s_add_u32 m0, s50, 53248
    s_nop 0
    buffer_load_dwordx4 v248, s[8:11], s54 offen lds
    s_add_u32 s54, s54, 114688
    s_cmp_eq_u32 s54, 1605632
    s_cselect_b32 s54, 0, s54
    s_add_u32 m0, s46, 320
    s_mov_b64 exec, 1
    buffer_load_dword v255, s[36:39], 0 offen lds
    s_mov_b64 exec, -1
    ds_read_b64_tr_b16 v[0:1], v250 offset:0
    ds_read_b64_tr_b16 v[2:3], v250 offset:512
    ds_read_b64_tr_b16 v[4:5], v250 offset:4096
    ds_read_b64_tr_b16 v[6:7], v250 offset:4608
    s_waitcnt lgkmcnt(3)
    v_dot2c_f32_bf16 v234, v59, v0
    v_dot2c_f32_bf16 v235, v59, v1
    s_waitcnt lgkmcnt(2)
    v_dot2c_f32_bf16 v234, v59, v2
    v_dot2c_f32_bf16 v235, v59, v3
    s_waitcnt lgkmcnt(1)
    v_dot2c_f32_bf16 v234, v59, v4
    v_dot2c_f32_bf16 v235, v59, v5
    s_waitcnt lgkmcnt(0)
    v_dot2c_f32_bf16 v234, v59, v6
    v_dot2c_f32_bf16 v235, v59, v7
    ds_read_b64_tr_b16 v[0:1], v250 offset:8192
    ds_read_b64_tr_b16 v[2:3], v250 offset:8704
    ds_read_b64_tr_b16 v[4:5], v250 offset:12288
    ds_read_b64_tr_b16 v[6:7], v250 offset:12800
    s_waitcnt lgkmcnt(3)
    v_dot2c_f32_bf16 v234, v59, v0
    v_dot2c_f32_bf16 v235, v59, v1
    s_waitcnt lgkmcnt(2)
    v_dot2c_f32_bf16 v234, v59, v2
    v_dot2c_f32_bf16 v235, v59, v3
    s_waitcnt lgkmcnt(1)
    v_dot2c_f32_bf16 v234, v59, v4
    v_dot2c_f32_bf16 v235, v59, v5
    s_waitcnt lgkmcnt(0)
    v_dot2c_f32_bf16 v234, v59, v6
    v_dot2c_f32_bf16 v235, v59, v7
    ds_read_b64_tr_b16 v[0:1], v250 offset:16384
    ds_read_b64_tr_b16 v[2:3], v250 offset:16896
    ds_read_b64_tr_b16 v[4:5], v250 offset:20480
    ds_read_b64_tr_b16 v[6:7], v250 offset:20992
    s_waitcnt lgkmcnt(3)
    v_dot2c_f32_bf16 v234, v59, v0
    v_dot2c_f32_bf16 v235, v59, v1
    s_waitcnt lgkmcnt(2)
    v_dot2c_f32_bf16 v234, v59, v2
    v_dot2c_f32_bf16 v235, v59, v3
    s_waitcnt lgkmcnt(1)
    v_dot2c_f32_bf16 v234, v59, v4
    v_dot2c_f32_bf16 v235, v59, v5
    s_waitcnt lgkmcnt(0)
    v_dot2c_f32_bf16 v234, v59, v6
    v_dot2c_f32_bf16 v235, v59, v7
    ds_read_b64_tr_b16 v[0:1], v250 offset:24576
    ds_read_b64_tr_b16 v[2:3], v250 offset:25088
    ds_read_b64_tr_b16 v[4:5], v250 offset:28672
    ds_read_b64_tr_b16 v[6:7], v250 offset:29184
    s_waitcnt lgkmcnt(3)
    v_dot2c_f32_bf16 v234, v59, v0
    v_dot2c_f32_bf16 v235, v59, v1
    s_waitcnt lgkmcnt(2)
    v_dot2c_f32_bf16 v234, v59, v2
    v_dot2c_f32_bf16 v235, v59, v3
    s_waitcnt lgkmcnt(1)
    v_dot2c_f32_bf16 v234, v59, v4
    v_dot2c_f32_bf16 v235, v59, v5
    s_waitcnt lgkmcnt(0)
    v_dot2c_f32_bf16 v234, v59, v6
    v_dot2c_f32_bf16 v235, v59, v7
    s_waitcnt vmcnt(7)
    ds_read_b64_tr_b16 v[0:1], v250 offset:32768
    ds_read_b64_tr_b16 v[2:3], v250 offset:33280
    ds_read_b64_tr_b16 v[4:5], v250 offset:36864
    ds_read_b64_tr_b16 v[6:7], v250 offset:37376
    s_waitcnt lgkmcnt(3)
    v_dot2c_f32_bf16 v234, v59, v0
    v_dot2c_f32_bf16 v235, v59, v1
    s_waitcnt lgkmcnt(2)
    v_dot2c_f32_bf16 v234, v59, v2
    v_dot2c_f32_bf16 v235, v59, v3
    s_waitcnt lgkmcnt(1)
    v_dot2c_f32_bf16 v234, v59, v4
    v_dot2c_f32_bf16 v235, v59, v5
    s_waitcnt lgkmcnt(0)
    v_dot2c_f32_bf16 v234, v59, v6
    v_dot2c_f32_bf16 v235, v59, v7
    s_waitcnt vmcnt(4)
    ds_read_b64_tr_b16 v[0:1], v250 offset:40960
    ds_read_b64_tr_b16 v[2:3], v250 offset:41472
    ds_read_b64_tr_b16 v[4:5], v250 offset:45056
    ds_read_b64_tr_b16 v[6:7], v250 offset:45568
    s_waitcnt lgkmcnt(3)
    v_dot2c_f32_bf16 v234, v59, v0
    v_dot2c_f32_bf16 v235, v59, v1
    s_waitcnt lgkmcnt(2)
    v_dot2c_f32_bf16 v234, v59, v2
    v_dot2c_f32_bf16 v235, v59, v3
    s_waitcnt lgkmcnt(1)
    v_dot2c_f32_bf16 v234, v59, v4
    v_dot2c_f32_bf16 v235, v59, v5
    s_waitcnt lgkmcnt(0)
    v_dot2c_f32_bf16 v234, v59, v6
    v_dot2c_f32_bf16 v235, v59, v7
    s_waitcnt vmcnt(1)
    ds_read_b64_tr_b16 v[0:1], v250 offset:49152
    ds_read_b64_tr_b16 v[2:3], v250 offset:49664
    ds_read_b64_tr_b16 v[4:5], v250 offset:53248
    ds_read_b64_tr_b16 v[6:7], v250 offset:53760
    s_waitcnt lgkmcnt(3)
    v_dot2c_f32_bf16 v234, v59, v0
    v_dot2c_f32_bf16 v235, v59, v1
    s_waitcnt lgkmcnt(2)
    v_dot2c_f32_bf16 v234, v59, v2
    v_dot2c_f32_bf16 v235, v59, v3
    s_waitcnt lgkmcnt(1)
    v_dot2c_f32_bf16 v234, v59, v4
    v_dot2c_f32_bf16 v235, v59, v5
    s_waitcnt lgkmcnt(0)
    v_dot2c_f32_bf16 v234, v59, v6
    v_dot2c_f32_bf16 v235, v59, v7
    s_nop 2
    v_add_f32 v234, v234, v235
    v_and_b32 v72, 0xffff0000, v234
    v_sub_f32 v234, v234, v72
    v_and_b32 v73, 0xffff0000, v234
    v_sub_f32 v234, v234, v73
    v_lshrrev_b32 v72, 16, v72
    v_or_b32 v74, v72, v73
    v_lshrrev_b32 v234, 16, v234
    v_lshl_or_b32 v75, v227, 16, v234
    ds_write_b64 v253, v[74:75] offset:0
    ds_write_b32 v254, v224 offset:672
    s_waitcnt vmcnt(0) lgkmcnt(0)
    s_branch RET_12
SLOW_13:
    s_mov_b32 s63, 0
ZS_39:
    s_sleep 2
    ds_read_b128 v[232:235], v255 offset:560
    s_add_u32 s63, s63, 1
    s_cmp_lt_u32 s63, 131072
    s_waitcnt lgkmcnt(0)
    v_or3_b32 v232, v232, v233, v234
    v_or_b32 v232, v232, v235
    v_cmp_ne_u32 vcc, 0, v232
    s_cbranch_scc0 ZD_40
    s_nop 3
    s_cbranch_vccnz ZS_39
ZD_40:
    s_branch RET_14
SLOW_15:
    s_mov_b32 s63, 0
NON_41:
    buffer_load_dwordx2 v[56:57], v58, s[36:39], 0 offen sc1
    s_waitcnt vmcnt(0)
    v_readfirstlane_b32 s60, v56
    v_readfirstlane_b32 s61, v57
    s_add_u32 s63, s63, 1
    s_cmp_gt_u32 s63, 0x8000
    s_cbranch_scc1 NOND_42
    s_cmp_lg_u32 s60, 0
    s_cbranch_scc1 NOND_42
    s_sleep 8
    s_branch NON_41
NOND_42:
    s_branch RET_16
SLOW_17:
    s_mov_b32 s63, 0
ZS_43:
    s_sleep 2
    ds_read_b128 v[232:235], v255 offset:576
    s_add_u32 s63, s63, 1
    s_cmp_lt_u32 s63, 131072
    s_waitcnt lgkmcnt(0)
    v_or3_b32 v232, v232, v233, v234
    v_or_b32 v232, v232, v235
    v_cmp_ne_u32 vcc, 0, v232
    s_cbranch_scc0 ZD_44
    s_nop 3
    s_cbranch_vccnz ZS_43
ZD_44:
    s_branch RET_18
SLOW_19:
    s_mov_b32 s63, 0
POLL_45:
    s_and_b32 exec_lo, s98, 16711680
    s_and_b32 exec_hi, s99, 0
    s_or_b32 exec_lo, exec_lo, 65536
    buffer_load_dwordx2 v[230:231], v238, s[16:19], 0 offen sc1
    s_mov_b64 exec, -1
    s_waitcnt vmcnt(0)
    v_cmp_ne_u64 vcc, s[60:61], v[230:231]
    s_nop 0
    s_and_b64 s[98:99], s[98:99], vcc
    s_and_b32 s62, s98, 16711680
    s_cbranch_scc0 POLLD_46
    s_sleep 8
    s_add_u32 s63, s63, 1
    s_cmp_lt_u32 s63, 0x8000
    s_cbranch_scc1 POLL_45
POLLD_46:
    s_branch RET_20
SLOW_21:
    s_mov_b32 s63, 0
POLL_47:
    s_and_b32 exec_lo, s98, 4278190080
    s_and_b32 exec_hi, s99, 0
    s_or_b32 exec_lo, exec_lo, 16777216
    buffer_load_dwordx2 v[230:231], v238, s[16:19], 0 offen sc1
    s_mov_b64 exec, -1
    s_waitcnt vmcnt(0)
    v_cmp_ne_u64 vcc, s[60:61], v[230:231]
    s_nop 0
    s_and_b64 s[98:99], s[98:99], vcc
    s_and_b32 s62, s98, 4278190080
    s_cbranch_scc0 POLLD_48
    s_sleep 8
    s_add_u32 s63, s63, 1
    s_cmp_lt_u32 s63, 0x8000
    s_cbranch_scc1 POLL_47
POLLD_48:
    s_branch RET_22
SLOW_23:
    s_mov_b32 s63, 0
POLL_49:
    s_and_b32 exec_lo, s98, 0
    s_and_b32 exec_hi, s99, 65283
    s_or_b32 exec_lo, exec_lo, 65536
    buffer_load_dwordx2 v[230:231], v238, s[16:19], 0 offen sc1
    s_mov_b64 exec, -1
    s_waitcnt vmcnt(0)
    v_cmp_ne_u64 vcc, s[60:61], v[230:231]
    s_nop 0
    s_and_b64 s[98:99], s[98:99], vcc
    s_and_b32 s62, s99, 3
    s_cbranch_scc0 POLLD_50
    s_sleep 8
    s_add_u32 s63, s63, 1
    s_cmp_lt_u32 s63, 0x8000
    s_cbranch_scc1 POLL_49
POLLD_50:
    s_branch RET_24
SLOW_25:
    s_mov_b32 s63, 0
POLL_51:
    s_and_b32 exec_lo, s98, 0
    s_and_b32 exec_hi, s99, 65280
    s_or_b32 exec_lo, exec_lo, 65536
    buffer_load_dwordx2 v[230:231], v238, s[16:19], 0 offen sc1
    s_mov_b64 exec, -1
    s_waitcnt vmcnt(0)
    v_cmp_ne_u64 vcc, s[60:61], v[230:231]
    s_nop 0
    s_and_b64 s[98:99], s[98:99], vcc
    s_and_b32 s62, s99, 65280
    s_cbranch_scc0 POLLD_52
    s_sleep 8
    s_add_u32 s63, s63, 1
    s_cmp_lt_u32 s63, 0x8000
    s_cbranch_scc1 POLL_51
POLLD_52:
    s_branch RET_26
SLOW_37:
    s_mov_b32 s63, 0
ZS_53:
    s_sleep 2
    ds_read_b128 v[76:79], v255 offset:560
    s_add_u32 s63, s63, 1
    s_cmp_lt_u32 s63, 131072
    s_waitcnt lgkmcnt(0)
    v_or3_b32 v76, v76, v77, v78
    v_or_b32 v76, v76, v79
    v_cmp_ne_u32 vcc, 0, v76
    s_cbranch_scc0 ZD_54
    s_nop 3
    s_cbranch_vccnz ZS_53
ZD_54:
    s_branch RET_38
G_prog:
    s_load_dwordx2 s[36:37], s[0:1], 72
    s_load_dwordx2 s[16:17], s[0:1], 80
    s_load_dwordx2 s[24:25], s[0:1], 48
    s_load_dwordx2 s[28:29], s[0:1], 16
    s_load_dwordx2 s[32:33], s[0:1], 64
    s_mov_b32 s38, 256
    s_mov_b32 s39, 0x20000
    s_mov_b32 s18, 15597568
    s_mov_b32 s19, 0x20000
    s_mov_b32 s26, 1605632
    s_mov_b32 s27, 0x20000
    s_mov_b32 s30, 401408
    s_mov_b32 s31, 0x20000
    s_mov_b32 s34, 1835008
    s_mov_b32 s35, 0x20000
    v_mov_b32 v255, 155648
    s_lshl_b32 s46, s40, 2
    s_add_u32 s46, s46, 155648
    v_lshl_add_u32 v243, v0, 2, v255
    ds_write_b32 v243, v255
    s_waitcnt lgkmcnt(0)
    s_barrier
    s_lshl_b32 s52, s2, 2
    s_add_u32 s52, s52, s40
    s_mul_i32 s53, s52, 1664
    s_lshl_b32 s52, s52, 9
    v_lshlrev_b32 v229, 7, v240
    s_mov_b64 exec, 0x1fff
    buffer_load_dword v231, v229, s[24:27], s53 offen
    s_mov_b64 exec, 0xf
    buffer_load_dword v228, v229, s[28:31], s52 offen
    s_mov_b64 exec, -1
    s_nop 4
    s_setprio 0
    v_and_b32 v250, 31, v240
    v_bfe_u32 v251, v240, 1, 3
    v_lshrrev_b32 v252, 5, v240
    v_xor_b32 v251, v251, v252
    v_lshlrev_b32 v224, 7, v250
    v_lshl_add_u32 v224, v251, 4, v224
    v_lshl_add_u32 v224, v241, 12, v224
    v_xor_b32 v225, 32, v224
    v_xor_b32 v226, 64, v224
    v_xor_b32 v227, 96, v224
    v_lshlrev_b32 v252, 2, v252
    v_sub_u32 v250, v250, v252
    v_cmp_le_i32 s[4:5], 0, v250
    v_cmp_le_i32 s[6:7], 1, v250
    v_cmp_le_i32 s[8:9], 2, v250
    v_cmp_le_i32 s[10:11], 3, v250
    v_cmp_le_i32 s[12:13], 8, v250
    v_cmp_le_i32 s[14:15], 9, v250
    v_cmp_le_i32 s[20:21], 10, v250
    v_cmp_le_i32 s[22:23], 11, v250
    v_cmp_le_i32 s[24:25], 16, v250
    v_cmp_le_i32 s[26:27], 17, v250
    v_cmp_le_i32 s[28:29], 18, v250
    v_cmp_le_i32 s[30:31], 19, v250
    v_cmp_le_i32 s[32:33], 24, v250
    v_cmp_le_i32 s[34:35], 25, v250
    v_cmp_le_i32 s[96:97], 26, v250
    v_cmp_le_i32 s[98:99], 27, v250
    v_bfe_u32 v248, v240, 4, 1
    v_lshlrev_b32 v248, 5, v248
    v_and_b32 v250, 1, v240
    v_lshl_add_u32 v248, v250, 4, v248
    v_bfe_u32 v250, v240, 1, 1
    v_lshl_add_u32 v248, v250, 3, v248
    v_lshrrev_b32 v250, 5, v240
    v_bfe_u32 v251, v240, 2, 2
    v_lshl_add_u32 v250, v250, 3, v251
    v_lshl_add_u32 v248, v250, 7, v248
    v_lshrrev_b32 v251, 1, v251
    v_lshl_add_u32 v248, v251, 6, v248
    v_xor_b32 v249, 64, v248
    v_add_u32 v250, 81920, v248
    v_add_u32 v251, 81920, v249
    v_lshlrev_b32 v252, 4, v240
    v_add_u32 v253, 156672, v252
    v_mov_b32 v241, 0
    v_mov_b32 v242, 0
    v_mov_b32 v243, 0
    v_mov_b32 v254, 0
    s_mov_b32 s53, 0x3f803f80
    s_mul_i32 s100, s43, 200704
    s_lshl_b32 s101, s43, 13
    s_add_u32 s101, s101, 14942208
    s_mov_b32 s63, 0
ZS_55:
    ds_read_b128 v[244:247], v255 offset:0
    s_add_u32 s63, s63, 1
    s_cmp_lt_u32 s63, 131072
    s_waitcnt lgkmcnt(0)
    v_or3_b32 v244, v244, v245, v246
    v_or_b32 v244, v244, v247
    v_cmp_ne_u32 vcc, 0, v244
    s_cbranch_scc0 ZD_56
    s_nop 3
    s_cbranch_vccnz ZS_55
ZD_56:
    ds_read_b128 v[0:3], v224
    ds_read_b128 v[4:7], v225
    ds_read_b128 v[8:11], v226
    ds_read_b128 v[12:15], v227
    ds_read_b64_tr_b16 v[176:177], v248 offset:16384
    ds_read_b64_tr_b16 v[178:179], v248 offset:16896
    ds_read_b64_tr_b16 v[180:181], v249 offset:16384
    ds_read_b64_tr_b16 v[182:183], v249 offset:16896
    ds_read_b64_tr_b16 v[184:185], v248 offset:24576
    ds_read_b64_tr_b16 v[186:187], v248 offset:25088
    ds_read_b64_tr_b16 v[188:189], v249 offset:24576
    ds_read_b64_tr_b16 v[190:191], v249 offset:25088
    ds_read_b64_tr_b16 v[192:193], v248 offset:18432
    ds_read_b64_tr_b16 v[194:195], v248 offset:18944
    ds_read_b64_tr_b16 v[196:197], v249 offset:18432
    ds_read_b64_tr_b16 v[198:199], v249 offset:18944
    ds_read_b64_tr_b16 v[200:201], v248 offset:26624
    ds_read_b64_tr_b16 v[202:203], v248 offset:27136
    ds_read_b64_tr_b16 v[204:205], v249 offset:26624
    ds_read_b64_tr_b16 v[206:207], v249 offset:27136
    s_waitcnt lgkmcnt(15)
    s_add_u32 m0, s46, 448
    s_mov_b64 exec, 1
    buffer_load_dword v255, s[36:39], 0 offen lds
    s_mov_b64 exec, -1
    v_dot2c_f32_bf16 v241, s53, v0
    v_dot2c_f32_bf16 v243, v0, v0
    v_dot2c_f32_bf16 v242, s53, v1
    v_dot2c_f32_bf16 v254, v1, v1
    v_dot2c_f32_bf16 v241, s53, v2
    v_dot2c_f32_bf16 v243, v2, v2
    v_dot2c_f32_bf16 v242, s53, v3
    v_dot2c_f32_bf16 v254, v3, v3
    v_dot2c_f32_bf16 v241, s53, v4
    v_dot2c_f32_bf16 v243, v4, v4
    v_dot2c_f32_bf16 v242, s53, v5
    v_dot2c_f32_bf16 v254, v5, v5
    v_dot2c_f32_bf16 v241, s53, v6
    v_dot2c_f32_bf16 v243, v6, v6
    v_dot2c_f32_bf16 v242, s53, v7
    v_dot2c_f32_bf16 v254, v7, v7
    v_dot2c_f32_bf16 v241, s53, v8
    v_dot2c_f32_bf16 v243, v8, v8
    v_dot2c_f32_bf16 v242, s53, v9
    v_dot2c_f32_bf16 v254, v9, v9
    v_dot2c_f32_bf16 v241, s53, v10
    v_dot2c_f32_bf16 v243, v10, v10
    v_dot2c_f32_bf16 v242, s53, v11
    v_dot2c_f32_bf16 v254, v11, v11
    v_dot2c_f32_bf16 v241, s53, v12
    v_dot2c_f32_bf16 v243, v12, v12
    v_dot2c_f32_bf16 v242, s53, v13
    v_dot2c_f32_bf16 v254, v13, v13
    v_dot2c_f32_bf16 v241, s53, v14
    v_dot2c_f32_bf16 v243, v14, v14
    v_dot2c_f32_bf16 v242, s53, v15
    v_dot2c_f32_bf16 v254, v15, v15
    s_waitcnt lgkmcnt(14)
    v_mfma_f32_32x32x16_bf16 v[112:127], v[176:179], v[0:3], 0
    ds_read_b128 v[244:247], v255 offset:16
    ds_read_b64_tr_b16 v[208:209], v248 offset:20480
    ds_read_b64_tr_b16 v[210:211], v248 offset:20992
    s_waitcnt lgkmcnt(15)
    v_mfma_f32_32x32x16_bf16 v[128:143], v[180:183], v[0:3], 0
    ds_read_b64_tr_b16 v[212:213], v249 offset:20480
    ds_read_b64_tr_b16 v[214:215], v249 offset:20992
    ds_read_b64_tr_b16 v[216:217], v248 offset:28672
    s_waitcnt lgkmcnt(15)
    v_mfma_f32_32x32x16_bf16 v[144:159], v[184:187], v[0:3], 0
    ds_read_b64_tr_b16 v[218:219], v248 offset:29184
    ds_read_b64_tr_b16 v[220:221], v249 offset:28672
    ds_read_b64_tr_b16 v[222:223], v249 offset:29184
    s_waitcnt lgkmcnt(15)
    v_mfma_f32_32x32x16_bf16 v[160:175], v[188:191], v[0:3], 0
    v_mfma_f32_32x32x16_bf16 v[112:127], v[192:195], v[4:7], v[112:127]
    ds_read_b64_tr_b16 v[176:177], v248 offset:22528
    ds_read_b64_tr_b16 v[178:179], v248 offset:23040
    s_waitcnt lgkmcnt(15)
    v_mfma_f32_32x32x16_bf16 v[128:143], v[196:199], v[4:7], v[128:143]
    ds_read_b64_tr_b16 v[180:181], v249 offset:22528
    ds_read_b64_tr_b16 v[182:183], v249 offset:23040
    s_waitcnt lgkmcnt(15)
    v_mfma_f32_32x32x16_bf16 v[144:159], v[200:203], v[4:7], v[144:159]
    ds_read_b64_tr_b16 v[184:185], v248 offset:30720
    ds_read_b64_tr_b16 v[186:187], v248 offset:31232
    s_waitcnt lgkmcnt(15)
    v_mfma_f32_32x32x16_bf16 v[160:175], v[204:207], v[4:7], v[160:175]
    ds_read_b64_tr_b16 v[188:189], v249 offset:30720
    ds_read_b64_tr_b16 v[190:191], v249 offset:31232
    s_waitcnt lgkmcnt(14)
    v_mfma_f32_32x32x16_bf16 v[112:127], v[208:211], v[8:11], v[112:127]
    v_or3_b32 v244, v244, v245, v246
    v_or_b32 v244, v244, v247
    v_cmp_ne_u32 vcc, 0, v244
    s_nop 4
    s_cbranch_vccnz SLOW_57
RET_58:
    ds_read_b64_tr_b16 v[192:193], v248 offset:49152
    ds_read_b64_tr_b16 v[194:195], v248 offset:49664
    ds_read_b64_tr_b16 v[196:197], v249 offset:49152
    ds_read_b64_tr_b16 v[198:199], v249 offset:49664
    s_waitcnt lgkmcnt(15)
    v_mfma_f32_32x32x16_bf16 v[128:143], v[212:215], v[8:11], v[128:143]
    ds_read_b64_tr_b16 v[200:201], v248 offset:57344
    ds_read_b64_tr_b16 v[202:203], v248 offset:57856
    ds_read_b64_tr_b16 v[204:205], v249 offset:57344
    ds_read_b64_tr_b16 v[206:207], v249 offset:57856
    v_add_u32 v224, 32768, v224
    s_waitcnt lgkmcnt(15)
    v_mfma_f32_32x32x16_bf16 v[144:159], v[216:219], v[8:11], v[144:159]
    v_add_u32 v225, 32768, v225
    v_add_u32 v226, 32768, v226
    v_add_u32 v227, 32768, v227
    ds_read_b128 v[16:19], v224
    ds_read_b128 v[20:23], v225
    v_mfma_f32_32x32x16_bf16 v[160:175], v[220:223], v[8:11], v[160:175]
    ds_read_b128 v[24:27], v226
    ds_read_b128 v[28:31], v227
    s_waitcnt lgkmcnt(15)
    v_mfma_f32_32x32x16_bf16 v[112:127], v[176:179], v[12:15], v[112:127]
    ds_read_b64_tr_b16 v[208:209], v248 offset:51200
    ds_read_b64_tr_b16 v[210:211], v248 offset:51712
    ds_read_b64_tr_b16 v[212:213], v249 offset:51200
    v_mfma_f32_32x32x16_bf16 v[128:143], v[180:183], v[12:15], v[128:143]
    ds_read_b64_tr_b16 v[214:215], v249 offset:51712
    ds_read_b64_tr_b16 v[216:217], v248 offset:59392
    ds_read_b64_tr_b16 v[218:219], v248 offset:59904
    s_waitcnt lgkmcnt(15)
    v_mfma_f32_32x32x16_bf16 v[144:159], v[184:187], v[12:15], v[144:159]
    ds_read_b64_tr_b16 v[220:221], v249 offset:59392
    ds_read_b64_tr_b16 v[222:223], v249 offset:59904
    s_waitcnt lgkmcnt(8)
    s_add_u32 m0, s46, 464
    s_mov_b64 exec, 1
    buffer_load_dword v255, s[36:39], 0 offen lds
    s_mov_b64 exec, -1
    v_mfma_f32_32x32x16_bf16 v[160:175], v[188:191], v[12:15], v[160:175]
    v_dot2c_f32_bf16 v241, s53, v16
    v_dot2c_f32_bf16 v243, v16, v16
    v_dot2c_f32_bf16 v242, s53, v17
    v_dot2c_f32_bf16 v254, v17, v17
    v_dot2c_f32_bf16 v241, s53, v18
    v_dot2c_f32_bf16 v243, v18, v18
    v_dot2c_f32_bf16 v242, s53, v19
    v_dot2c_f32_bf16 v254, v19, v19
    v_dot2c_f32_bf16 v241, s53, v20
    v_dot2c_f32_bf16 v243, v20, v20
    v_dot2c_f32_bf16 v242, s53, v21
    v_dot2c_f32_bf16 v254, v21, v21
    v_dot2c_f32_bf16 v241, s53, v22
    v_dot2c_f32_bf16 v243, v22, v22
    v_dot2c_f32_bf16 v242, s53, v23
    v_dot2c_f32_bf16 v254, v23, v23
    v_dot2c_f32_bf16 v241, s53, v24
    v_dot2c_f32_bf16 v243, v24, v24
    v_dot2c_f32_bf16 v242, s53, v25
    v_dot2c_f32_bf16 v254, v25, v25
    v_dot2c_f32_bf16 v241, s53, v26
    v_dot2c_f32_bf16 v243, v26, v26
    v_dot2c_f32_bf16 v242, s53, v27
    v_dot2c_f32_bf16 v254, v27, v27
    v_dot2c_f32_bf16 v241, s53, v28
    v_dot2c_f32_bf16 v243, v28, v28
    v_dot2c_f32_bf16 v242, s53, v29
    v_dot2c_f32_bf16 v254, v29, v29
    v_dot2c_f32_bf16 v241, s53, v30
    v_dot2c_f32_bf16 v243, v30, v30
    v_dot2c_f32_bf16 v242, s53, v31
    v_dot2c_f32_bf16 v254, v31, v31
    v_mfma_f32_32x32x16_bf16 v[112:127], v[192:195], v[16:19], v[112:127]
    ds_read_b128 v[244:247], v255 offset:32
    ds_read_b64_tr_b16 v[176:177], v248 offset:53248
    ds_read_b64_tr_b16 v[178:179], v248 offset:53760
    v_mfma_f32_32x32x16_bf16 v[128:143], v[196:199], v[16:19], v[128:143]
    ds_read_b64_tr_b16 v[180:181], v249 offset:53248
    ds_read_b64_tr_b16 v[182:183], v249 offset:53760
    ds_read_b64_tr_b16 v[184:185], v248 offset:61440
    v_mfma_f32_32x32x16_bf16 v[144:159], v[200:203], v[16:19], v[144:159]
    ds_read_b64_tr_b16 v[186:187], v248 offset:61952
    ds_read_b64_tr_b16 v[188:189], v249 offset:61440
    ds_read_b64_tr_b16 v[190:191], v249 offset:61952
    v_mfma_f32_32x32x16_bf16 v[160:175], v[204:207], v[16:19], v[160:175]
    s_waitcnt lgkmcnt(15)
    v_mfma_f32_32x32x16_bf16 v[112:127], v[208:211], v[20:23], v[112:127]
    ds_read_b64_tr_b16 v[192:193], v248 offset:55296
    ds_read_b64_tr_b16 v[194:195], v248 offset:55808
    s_waitcnt lgkmcnt(15)
    v_mfma_f32_32x32x16_bf16 v[128:143], v[212:215], v[20:23], v[128:143]
    ds_read_b64_tr_b16 v[196:197], v249 offset:55296
    ds_read_b64_tr_b16 v[198:199], v249 offset:55808
    s_waitcnt lgkmcnt(15)
    v_mfma_f32_32x32x16_bf16 v[144:159], v[216:219], v[20:23], v[144:159]
    ds_read_b64_tr_b16 v[200:201], v248 offset:63488
    ds_read_b64_tr_b16 v[202:203], v248 offset:64000
    s_waitcnt lgkmcnt(15)
    v_mfma_f32_32x32x16_bf16 v[160:175], v[220:223], v[20:23], v[160:175]
    ds_read_b64_tr_b16 v[204:205], v249 offset:63488
    ds_read_b64_tr_b16 v[206:207], v249 offset:64000
    s_waitcnt lgkmcnt(14)
    v_mfma_f32_32x32x16_bf16 v[112:127], v[176:179], v[24:27], v[112:127]
    v_or3_b32 v244, v244, v245, v246
    v_or_b32 v244, v244, v247
    v_cmp_ne_u32 vcc, 0, v244
    s_nop 4
    s_cbranch_vccnz SLOW_59
RET_60:
    ds_read_b64_tr_b16 v[208:209], v250 offset:0
    ds_read_b64_tr_b16 v[210:211], v250 offset:512
    ds_read_b64_tr_b16 v[212:213], v251 offset:0
    ds_read_b64_tr_b16 v[214:215], v251 offset:512
    s_waitcnt lgkmcnt(15)
    v_mfma_f32_32x32x16_bf16 v[128:143], v[180:183], v[24:27], v[128:143]
    ds_read_b64_tr_b16 v[216:217], v250 offset:8192
    ds_read_b64_tr_b16 v[218:219], v250 offset:8704
    ds_read_b64_tr_b16 v[220:221], v251 offset:8192
    ds_read_b64_tr_b16 v[222:223], v251 offset:8704
    v_add_u32 v224, 32768, v224
    s_waitcnt lgkmcnt(15)
    v_mfma_f32_32x32x16_bf16 v[144:159], v[184:187], v[24:27], v[144:159]
    v_add_u32 v225, 32768, v225
    v_add_u32 v226, 32768, v226
    v_add_u32 v227, 32768, v227
    ds_read_b128 v[32:35], v224
    ds_read_b128 v[36:39], v225
    v_mfma_f32_32x32x16_bf16 v[160:175], v[188:191], v[24:27], v[160:175]
    ds_read_b128 v[40:43], v226
    ds_read_b128 v[44:47], v227
    s_waitcnt lgkmcnt(15)
    v_mfma_f32_32x32x16_bf16 v[112:127], v[192:195], v[28:31], v[112:127]
    ds_read_b64_tr_b16 v[176:177], v250 offset:2048
    ds_read_b64_tr_b16 v[178:179], v250 offset:2560
    ds_read_b64_tr_b16 v[180:181], v251 offset:2048
    v_mfma_f32_32x32x16_bf16 v[128:143], v[196:199], v[28:31], v[128:143]
    ds_read_b64_tr_b16 v[182:183], v251 offset:2560
    ds_read_b64_tr_b16 v[184:185], v250 offset:10240
    ds_read_b64_tr_b16 v[186:187], v250 offset:10752
    s_waitcnt lgkmcnt(15)
    v_mfma_f32_32x32x16_bf16 v[144:159], v[200:203], v[28:31], v[144:159]
    ds_read_b64_tr_b16 v[188:189], v251 offset:10240
    ds_read_b64_tr_b16 v[190:191], v251 offset:10752
    s_waitcnt lgkmcnt(8)
    s_add_u32 m0, s46, 480
    s_mov_b64 exec, 1
    buffer_load_dword v255, s[36:39], 0 offen lds
    s_mov_b64 exec, -1
    v_mfma_f32_32x32x16_bf16 v[160:175], v[204:207], v[28:31], v[160:175]
    v_dot2c_f32_bf16 v241, s53, v32
    v_dot2c_f32_bf16 v243, v32, v32
    v_dot2c_f32_bf16 v242, s53, v33
    v_dot2c_f32_bf16 v254, v33, v33
    v_dot2c_f32_bf16 v241, s53, v34
    v_dot2c_f32_bf16 v243, v34, v34
    v_dot2c_f32_bf16 v242, s53, v35
    v_dot2c_f32_bf16 v254, v35, v35
    v_dot2c_f32_bf16 v241, s53, v36
    v_dot2c_f32_bf16 v243, v36, v36
    v_dot2c_f32_bf16 v242, s53, v37
    v_dot2c_f32_bf16 v254, v37, v37
    v_dot2c_f32_bf16 v241, s53, v38
    v_dot2c_f32_bf16 v243, v38, v38
    v_dot2c_f32_bf16 v242, s53, v39
    v_dot2c_f32_bf16 v254, v39, v39
    v_dot2c_f32_bf16 v241, s53, v40
    v_dot2c_f32_bf16 v243, v40, v40
    v_dot2c_f32_bf16 v242, s53, v41
    v_dot2c_f32_bf16 v254, v41, v41
    v_dot2c_f32_bf16 v241, s53, v42
    v_dot2c_f32_bf16 v243, v42, v42
    v_dot2c_f32_bf16 v242, s53, v43
    v_dot2c_f32_bf16 v254, v43, v43
    v_dot2c_f32_bf16 v241, s53, v44
    v_dot2c_f32_bf16 v243, v44, v44
    v_dot2c_f32_bf16 v242, s53, v45
    v_dot2c_f32_bf16 v254, v45, v45
    v_dot2c_f32_bf16 v241, s53, v46
    v_dot2c_f32_bf16 v243, v46, v46
    v_dot2c_f32_bf16 v242, s53, v47
    v_dot2c_f32_bf16 v254, v47, v47
    v_mfma_f32_32x32x16_bf16 v[112:127], v[208:211], v[32:35], v[112:127]
    ds_read_b128 v[244:247], v255 offset:48
    ds_read_b64_tr_b16 v[192:193], v250 offset:4096
    ds_read_b64_tr_b16 v[194:195], v250 offset:4608
    v_mfma_f32_32x32x16_bf16 v[128:143], v[212:215], v[32:35], v[128:143]
    ds_read_b64_tr_b16 v[196:197], v251 offset:4096
    ds_read_b64_tr_b16 v[198:199], v251 offset:4608
    ds_read_b64_tr_b16 v[200:201], v250 offset:12288
    v_mfma_f32_32x32x16_bf16 v[144:159], v[216:219], v[32:35], v[144:159]
    ds_read_b64_tr_b16 v[202:203], v250 offset:12800
    ds_read_b64_tr_b16 v[204:205], v251 offset:12288
    ds_read_b64_tr_b16 v[206:207], v251 offset:12800
    v_mfma_f32_32x32x16_bf16 v[160:175], v[220:223], v[32:35], v[160:175]
    s_waitcnt lgkmcnt(15)
    v_mfma_f32_32x32x16_bf16 v[112:127], v[176:179], v[36:39], v[112:127]
    ds_read_b64_tr_b16 v[208:209], v250 offset:6144
    ds_read_b64_tr_b16 v[210:211], v250 offset:6656
    s_waitcnt lgkmcnt(15)
    v_mfma_f32_32x32x16_bf16 v[128:143], v[180:183], v[36:39], v[128:143]
    ds_read_b64_tr_b16 v[212:213], v251 offset:6144
    ds_read_b64_tr_b16 v[214:215], v251 offset:6656
    s_waitcnt lgkmcnt(15)
    v_mfma_f32_32x32x16_bf16 v[144:159], v[184:187], v[36:39], v[144:159]
    ds_read_b64_tr_b16 v[216:217], v250 offset:14336
    ds_read_b64_tr_b16 v[218:219], v250 offset:14848
    s_waitcnt lgkmcnt(15)
    v_mfma_f32_32x32x16_bf16 v[160:175], v[188:191], v[36:39], v[160:175]
    ds_read_b64_tr_b16 v[220:221], v251 offset:14336
    ds_read_b64_tr_b16 v[222:223], v251 offset:14848
    s_waitcnt lgkmcnt(14)
    v_mfma_f32_32x32x16_bf16 v[112:127], v[192:195], v[40:43], v[112:127]
    v_or3_b32 v244, v244, v245, v246
    v_or_b32 v244, v244, v247
    v_cmp_ne_u32 vcc, 0, v244
    s_nop 4
    s_cbranch_vccnz SLOW_61
RET_62:
    ds_read_b64_tr_b16 v[176:177], v250 offset:32768
    ds_read_b64_tr_b16 v[178:179], v250 offset:33280
    ds_read_b64_tr_b16 v[180:181], v251 offset:32768
    ds_read_b64_tr_b16 v[182:183], v251 offset:33280
    s_waitcnt lgkmcnt(15)
    v_mfma_f32_32x32x16_bf16 v[128:143], v[196:199], v[40:43], v[128:143]
    ds_read_b64_tr_b16 v[184:185], v250 offset:40960
    ds_read_b64_tr_b16 v[186:187], v250 offset:41472
    ds_read_b64_tr_b16 v[188:189], v251 offset:40960
    ds_read_b64_tr_b16 v[190:191], v251 offset:41472
    v_add_u32 v224, 32768, v224
    s_waitcnt lgkmcnt(15)
    v_mfma_f32_32x32x16_bf16 v[144:159], v[200:203], v[40:43], v[144:159]
    v_add_u32 v225, 32768, v225
    v_add_u32 v226, 32768, v226
    v_add_u32 v227, 32768, v227
    ds_read_b128 v[48:51], v224
    ds_read_b128 v[52:55], v225
    v_mfma_f32_32x32x16_bf16 v[160:175], v[204:207], v[40:43], v[160:175]
    ds_read_b128 v[56:59], v226
    ds_read_b128 v[60:63], v227
    s_waitcnt lgkmcnt(15)
    v_mfma_f32_32x32x16_bf16 v[112:127], v[208:211], v[44:47], v[112:127]
    ds_read_b64_tr_b16 v[192:193], v250 offset:34816
    ds_read_b64_tr_b16 v[194:195], v250 offset:35328
    ds_read_b64_tr_b16 v[196:197], v251 offset:34816
    v_mfma_f32_32x32x16_bf16 v[128:143], v[212:215], v[44:47], v[128:143]
    ds_read_b64_tr_b16 v[198:199], v251 offset:35328
    ds_read_b64_tr_b16 v[200:201], v250 offset:43008
    ds_read_b64_tr_b16 v[202:203], v250 offset:43520
    s_waitcnt lgkmcnt(15)
    v_mfma_f32_32x32x16_bf16 v[144:159], v[216:219], v[44:47], v[144:159]
    ds_read_b64_tr_b16 v[204:205], v251 offset:43008
    ds_read_b64_tr_b16 v[206:207], v251 offset:43520
    s_waitcnt lgkmcnt(8)
    s_add_u32 m0, s46, 496
    s_mov_b64 exec, 1
    buffer_load_dword v255, s[36:39], 0 offen lds
    s_mov_b64 exec, -1
    v_mfma_f32_32x32x16_bf16 v[160:175], v[220:223], v[44:47], v[160:175]
    v_dot2c_f32_bf16 v241, s53, v48
    v_dot2c_f32_bf16 v243, v48, v48
    v_dot2c_f32_bf16 v242, s53, v49
    v_dot2c_f32_bf16 v254, v49, v49
    v_dot2c_f32_bf16 v241, s53, v50
    v_dot2c_f32_bf16 v243, v50, v50
    v_dot2c_f32_bf16 v242, s53, v51
    v_dot2c_f32_bf16 v254, v51, v51
    v_dot2c_f32_bf16 v241, s53, v52
    v_dot2c_f32_bf16 v243, v52, v52
    v_dot2c_f32_bf16 v242, s53, v53
    v_dot2c_f32_bf16 v254, v53, v53
    v_dot2c_f32_bf16 v241, s53, v54
    v_dot2c_f32_bf16 v243, v54, v54
    v_dot2c_f32_bf16 v242, s53, v55
    v_dot2c_f32_bf16 v254, v55, v55
    v_dot2c_f32_bf16 v241, s53, v56
    v_dot2c_f32_bf16 v243, v56, v56
    v_dot2c_f32_bf16 v242, s53, v57
    v_dot2c_f32_bf16 v254, v57, v57
    v_dot2c_f32_bf16 v241, s53, v58
    v_dot2c_f32_bf16 v243, v58, v58
    v_dot2c_f32_bf16 v242, s53, v59
    v_dot2c_f32_bf16 v254, v59, v59
    v_dot2c_f32_bf16 v241, s53, v60
    v_dot2c_f32_bf16 v243, v60, v60
    v_dot2c_f32_bf16 v242, s53, v61
    v_dot2c_f32_bf16 v254, v61, v61
    v_dot2c_f32_bf16 v241, s53, v62
    v_dot2c_f32_bf16 v243, v62, v62
    v_dot2c_f32_bf16 v242, s53, v63
    v_dot2c_f32_bf16 v254, v63, v63
    v_mfma_f32_32x32x16_bf16 v[112:127], v[176:179], v[48:51], v[112:127]
    ds_read_b128 v[244:247], v255 offset:64
    ds_read_b64_tr_b16 v[208:209], v250 offset:36864
    ds_read_b64_tr_b16 v[210:211], v250 offset:37376
    v_mfma_f32_32x32x16_bf16 v[128:143], v[180:183], v[48:51], v[128:143]
    ds_read_b64_tr_b16 v[212:213], v251 offset:36864
    ds_read_b64_tr_b16 v[214:215], v251 offset:37376
    ds_read_b64_tr_b16 v[216:217], v250 offset:45056
    v_mfma_f32_32x32x16_bf16 v[144:159], v[184:187], v[48:51], v[144:159]
    ds_read_b64_tr_b16 v[218:219], v250 offset:45568
    ds_read_b64_tr_b16 v[220:221], v251 offset:45056
    ds_read_b64_tr_b16 v[222:223], v251 offset:45568
    v_mfma_f32_32x32x16_bf16 v[160:175], v[188:191], v[48:51], v[160:175]
    s_waitcnt lgkmcnt(15)
    v_mfma_f32_32x32x16_bf16 v[112:127], v[192:195], v[52:55], v[112:127]
    ds_read_b64_tr_b16 v[176:177], v250 offset:38912
    ds_read_b64_tr_b16 v[178:179], v250 offset:39424
    s_waitcnt lgkmcnt(15)
    v_mfma_f32_32x32x16_bf16 v[128:143], v[196:199], v[52:55], v[128:143]
    ds_read_b64_tr_b16 v[180:181], v251 offset:38912
    ds_read_b64_tr_b16 v[182:183], v251 offset:39424
    s_waitcnt lgkmcnt(15)
    v_mfma_f32_32x32x16_bf16 v[144:159], v[200:203], v[52:55], v[144:159]
    ds_read_b64_tr_b16 v[184:185], v250 offset:47104
    ds_read_b64_tr_b16 v[186:187], v250 offset:47616
    s_waitcnt lgkmcnt(15)
    v_mfma_f32_32x32x16_bf16 v[160:175], v[204:207], v[52:55], v[160:175]
    ds_read_b64_tr_b16 v[188:189], v251 offset:47104
    ds_read_b64_tr_b16 v[190:191], v251 offset:47616
    s_waitcnt lgkmcnt(14)
    v_mfma_f32_32x32x16_bf16 v[112:127], v[208:211], v[56:59], v[112:127]
    v_or3_b32 v244, v244, v245, v246
    v_or_b32 v244, v244, v247
    v_cmp_ne_u32 vcc, 0, v244
    s_nop 4
    s_cbranch_vccnz SLOW_63
RET_64:
    ds_read_b64_tr_b16 v[192:193], v248 offset:0
    ds_read_b64_tr_b16 v[194:195], v248 offset:512
    ds_read_b64_tr_b16 v[196:197], v249 offset:0
    ds_read_b64_tr_b16 v[198:199], v249 offset:512
    s_waitcnt lgkmcnt(15)
    v_mfma_f32_32x32x16_bf16 v[128:143], v[212:215], v[56:59], v[128:143]
    ds_read_b64_tr_b16 v[200:201], v248 offset:8192
    ds_read_b64_tr_b16 v[202:203], v248 offset:8704
    ds_read_b64_tr_b16 v[204:205], v249 offset:8192
    ds_read_b64_tr_b16 v[206:207], v249 offset:8704
    v_add_u32 v224, 32768, v224
    s_waitcnt lgkmcnt(15)
    v_mfma_f32_32x32x16_bf16 v[144:159], v[216:219], v[56:59], v[144:159]
    v_add_u32 v225, 32768, v225
    v_add_u32 v226, 32768, v226
    v_add_u32 v227, 32768, v227
    ds_read_b128 v[64:67], v224
    ds_read_b128 v[68:71], v225
    v_mfma_f32_32x32x16_bf16 v[160:175], v[220:223], v[56:59], v[160:175]
    ds_read_b128 v[72:75], v226
    ds_read_b128 v[76:79], v227
    s_waitcnt lgkmcnt(15)
    v_mfma_f32_32x32x16_bf16 v[112:127], v[176:179], v[60:63], v[112:127]
    ds_read_b64_tr_b16 v[208:209], v248 offset:2048
    ds_read_b64_tr_b16 v[210:211], v248 offset:2560
    ds_read_b64_tr_b16 v[212:213], v249 offset:2048
    v_mfma_f32_32x32x16_bf16 v[128:143], v[180:183], v[60:63], v[128:143]
    ds_read_b64_tr_b16 v[214:215], v249 offset:2560
    ds_read_b64_tr_b16 v[216:217], v248 offset:10240
    ds_read_b64_tr_b16 v[218:219], v248 offset:10752
    s_waitcnt lgkmcnt(15)
    v_mfma_f32_32x32x16_bf16 v[144:159], v[184:187], v[60:63], v[144:159]
    ds_read_b64_tr_b16 v[220:221], v249 offset:10240
    ds_read_b64_tr_b16 v[222:223], v249 offset:10752
    s_waitcnt lgkmcnt(8)
    s_add_u32 m0, s46, 512
    s_mov_b64 exec, 1
    buffer_load_dword v255, s[36:39], 0 offen lds
    s_mov_b64 exec, -1
    v_mfma_f32_32x32x16_bf16 v[160:175], v[188:191], v[60:63], v[160:175]
    v_dot2c_f32_bf16 v241, s53, v64
    v_dot2c_f32_bf16 v243, v64, v64
    v_dot2c_f32_bf16 v242, s53, v65
    v_dot2c_f32_bf16 v254, v65, v65
    v_dot2c_f32_bf16 v241, s53, v66
    v_dot2c_f32_bf16 v243, v66, v66
    v_dot2c_f32_bf16 v242, s53, v67
    v_dot2c_f32_bf16 v254, v67, v67
    v_dot2c_f32_bf16 v241, s53, v68
    v_dot2c_f32_bf16 v243, v68, v68
    v_dot2c_f32_bf16 v242, s53, v69
    v_dot2c_f32_bf16 v254, v69, v69
    v_dot2c_f32_bf16 v241, s53, v70
    v_dot2c_f32_bf16 v243, v70, v70
    v_dot2c_f32_bf16 v242, s53, v71
    v_dot2c_f32_bf16 v254, v71, v71
    v_dot2c_f32_bf16 v241, s53, v72
    v_dot2c_f32_bf16 v243, v72, v72
    v_dot2c_f32_bf16 v242, s53, v73
    v_dot2c_f32_bf16 v254, v73, v73
    v_dot2c_f32_bf16 v241, s53, v74
    v_dot2c_f32_bf16 v243, v74, v74
    v_dot2c_f32_bf16 v242, s53, v75
    v_dot2c_f32_bf16 v254, v75, v75
    v_dot2c_f32_bf16 v241, s53, v76
    v_dot2c_f32_bf16 v243, v76, v76
    v_dot2c_f32_bf16 v242, s53, v77
    v_dot2c_f32_bf16 v254, v77, v77
    v_dot2c_f32_bf16 v241, s53, v78
    v_dot2c_f32_bf16 v243, v78, v78
    v_dot2c_f32_bf16 v242, s53, v79
    v_dot2c_f32_bf16 v254, v79, v79
    v_mfma_f32_32x32x16_bf16 v[112:127], v[192:195], v[64:67], v[112:127]
    ds_read_b128 v[244:247], v255 offset:80
    ds_read_b64_tr_b16 v[176:177], v248 offset:4096
    ds_read_b64_tr_b16 v[178:179], v248 offset:4608
    v_mfma_f32_32x32x16_bf16 v[128:143], v[196:199], v[64:67], v[128:143]
    ds_read_b64_tr_b16 v[180:181], v249 offset:4096
    ds_read_b64_tr_b16 v[182:183], v249 offset:4608
    ds_read_b64_tr_b16 v[184:185], v248 offset:12288
    v_mfma_f32_32x32x16_bf16 v[144:159], v[200:203], v[64:67], v[144:159]
    ds_read_b64_tr_b16 v[186:187], v248 offset:12800
    ds_read_b64_tr_b16 v[188:189], v249 offset:12288
    ds_read_b64_tr_b16 v[190:191], v249 offset:12800
    v_mfma_f32_32x32x16_bf16 v[160:175], v[204:207], v[64:67], v[160:175]
    s_waitcnt lgkmcnt(15)
    v_mfma_f32_32x32x16_bf16 v[112:127], v[208:211], v[68:71], v[112:127]
    ds_read_b64_tr_b16 v[192:193], v248 offset:6144
    ds_read_b64_tr_b16 v[194:195], v248 offset:6656
    s_waitcnt lgkmcnt(15)
    v_mfma_f32_32x32x16_bf16 v[128:143], v[212:215], v[68:71], v[128:143]
    ds_read_b64_tr_b16 v[196:197], v249 offset:6144
    ds_read_b64_tr_b16 v[198:199], v249 offset:6656
    s_waitcnt lgkmcnt(15)
    v_mfma_f32_32x32x16_bf16 v[144:159], v[216:219], v[68:71], v[144:159]
    ds_read_b64_tr_b16 v[200:201], v248 offset:14336
    ds_read_b64_tr_b16 v[202:203], v248 offset:14848
    s_waitcnt lgkmcnt(15)
    v_mfma_f32_32x32x16_bf16 v[160:175], v[220:223], v[68:71], v[160:175]
    ds_read_b64_tr_b16 v[204:205], v249 offset:14336
    ds_read_b64_tr_b16 v[206:207], v249 offset:14848
    s_waitcnt lgkmcnt(14)
    v_mfma_f32_32x32x16_bf16 v[112:127], v[176:179], v[72:75], v[112:127]
    v_or3_b32 v244, v244, v245, v246
    v_or_b32 v244, v244, v247
    v_cmp_ne_u32 vcc, 0, v244
    s_nop 4
    s_cbranch_vccnz SLOW_65
RET_66:
    ds_read_b64_tr_b16 v[208:209], v248 offset:16384
    ds_read_b64_tr_b16 v[210:211], v248 offset:16896
    ds_read_b64_tr_b16 v[212:213], v249 offset:16384
    ds_read_b64_tr_b16 v[214:215], v249 offset:16896
    s_waitcnt lgkmcnt(15)
    v_mfma_f32_32x32x16_bf16 v[128:143], v[180:183], v[72:75], v[128:143]
    ds_read_b64_tr_b16 v[216:217], v248 offset:24576
    ds_read_b64_tr_b16 v[218:219], v248 offset:25088
    ds_read_b64_tr_b16 v[220:221], v249 offset:24576
    ds_read_b64_tr_b16 v[222:223], v249 offset:25088
    v_subrev_u32 v224, 98304, v224
    s_waitcnt lgkmcnt(15)
    v_mfma_f32_32x32x16_bf16 v[144:159], v[184:187], v[72:75], v[144:159]
    v_subrev_u32 v225, 98304, v225
    v_subrev_u32 v226, 98304, v226
    v_subrev_u32 v227, 98304, v227
    ds_read_b128 v[80:83], v224
    ds_read_b128 v[84:87], v225
    v_mfma_f32_32x32x16_bf16 v[160:175], v[188:191], v[72:75], v[160:175]
    ds_read_b128 v[88:91], v226
    ds_read_b128 v[92:95], v227
    s_waitcnt lgkmcnt(15)
    v_mfma_f32_32x32x16_bf16 v[112:127], v[192:195], v[76:79], v[112:127]
    ds_read_b64_tr_b16 v[176:177], v248 offset:18432
    ds_read_b64_tr_b16 v[178:179], v248 offset:18944
    ds_read_b64_tr_b16 v[180:181], v249 offset:18432
    v_mfma_f32_32x32x16_bf16 v[128:143], v[196:199], v[76:79], v[128:143]
    ds_read_b64_tr_b16 v[182:183], v249 offset:18944
    ds_read_b64_tr_b16 v[184:185], v248 offset:26624
    ds_read_b64_tr_b16 v[186:187], v248 offset:27136
    s_waitcnt lgkmcnt(15)
    v_mfma_f32_32x32x16_bf16 v[144:159], v[200:203], v[76:79], v[144:159]
    ds_read_b64_tr_b16 v[188:189], v249 offset:26624
    ds_read_b64_tr_b16 v[190:191], v249 offset:27136
    s_waitcnt lgkmcnt(8)
    s_add_u32 m0, s46, 528
    s_mov_b64 exec, 1
    buffer_load_dword v255, s[36:39], 0 offen lds
    s_mov_b64 exec, -1
    v_mfma_f32_32x32x16_bf16 v[160:175], v[204:207], v[76:79], v[160:175]
    v_dot2c_f32_bf16 v241, s53, v80
    v_dot2c_f32_bf16 v243, v80, v80
    v_dot2c_f32_bf16 v242, s53, v81
    v_dot2c_f32_bf16 v254, v81, v81
    v_dot2c_f32_bf16 v241, s53, v82
    v_dot2c_f32_bf16 v243, v82, v82
    v_dot2c_f32_bf16 v242, s53, v83
    v_dot2c_f32_bf16 v254, v83, v83
    v_dot2c_f32_bf16 v241, s53, v84
    v_dot2c_f32_bf16 v243, v84, v84
    v_dot2c_f32_bf16 v242, s53, v85
    v_dot2c_f32_bf16 v254, v85, v85
    v_dot2c_f32_bf16 v241, s53, v86
    v_dot2c_f32_bf16 v243, v86, v86
    v_dot2c_f32_bf16 v242, s53, v87
    v_dot2c_f32_bf16 v254, v87, v87
    v_dot2c_f32_bf16 v241, s53, v88
    v_dot2c_f32_bf16 v243, v88, v88
    v_dot2c_f32_bf16 v242, s53, v89
    v_dot2c_f32_bf16 v254, v89, v89
    v_dot2c_f32_bf16 v241, s53, v90
    v_dot2c_f32_bf16 v243, v90, v90
    v_dot2c_f32_bf16 v242, s53, v91
    v_dot2c_f32_bf16 v254, v91, v91
    v_dot2c_f32_bf16 v241, s53, v92
    v_dot2c_f32_bf16 v243, v92, v92
    v_dot2c_f32_bf16 v242, s53, v93
    v_dot2c_f32_bf16 v254, v93, v93
    v_dot2c_f32_bf16 v241, s53, v94
    v_dot2c_f32_bf16 v243, v94, v94
    v_dot2c_f32_bf16 v242, s53, v95
    v_dot2c_f32_bf16 v254, v95, v95
    v_mfma_f32_32x32x16_bf16 v[112:127], v[208:211], v[80:83], v[112:127]
    ds_read_b128 v[244:247], v255 offset:96
    ds_read_b64_tr_b16 v[192:193], v248 offset:20480
    ds_read_b64_tr_b16 v[194:195], v248 offset:20992
    v_mfma_f32_32x32x16_bf16 v[128:143], v[212:215], v[80:83], v[128:143]
    ds_read_b64_tr_b16 v[196:197], v249 offset:20480
    ds_read_b64_tr_b16 v[198:199], v249 offset:20992
    ds_read_b64_tr_b16 v[200:201], v248 offset:28672
    v_mfma_f32_32x32x16_bf16 v[144:159], v[216:219], v[80:83], v[144:159]
    ds_read_b64_tr_b16 v[202:203], v248 offset:29184
    ds_read_b64_tr_b16 v[204:205], v249 offset:28672
    ds_read_b64_tr_b16 v[206:207], v249 offset:29184
    v_mfma_f32_32x32x16_bf16 v[160:175], v[220:223], v[80:83], v[160:175]
    s_waitcnt lgkmcnt(15)
    v_mfma_f32_32x32x16_bf16 v[112:127], v[176:179], v[84:87], v[112:127]
    ds_read_b64_tr_b16 v[208:209], v248 offset:22528
    ds_read_b64_tr_b16 v[210:211], v248 offset:23040
    s_waitcnt lgkmcnt(15)
    v_mfma_f32_32x32x16_bf16 v[128:143], v[180:183], v[84:87], v[128:143]
    ds_read_b64_tr_b16 v[212:213], v249 offset:22528
    ds_read_b64_tr_b16 v[214:215], v249 offset:23040
    s_waitcnt lgkmcnt(15)
    v_mfma_f32_32x32x16_bf16 v[144:159], v[184:187], v[84:87], v[144:159]
    ds_read_b64_tr_b16 v[216:217], v248 offset:30720
    ds_read_b64_tr_b16 v[218:219], v248 offset:31232
    s_waitcnt lgkmcnt(15)
    v_mfma_f32_32x32x16_bf16 v[160:175], v[188:191], v[84:87], v[160:175]
    ds_read_b64_tr_b16 v[220:221], v249 offset:30720
    ds_read_b64_tr_b16 v[222:223], v249 offset:31232
    s_waitcnt lgkmcnt(14)
    v_mfma_f32_32x32x16_bf16 v[112:127], v[192:195], v[88:91], v[112:127]
    v_or3_b32 v244, v244, v245, v246
    v_or_b32 v244, v244, v247
    v_cmp_ne_u32 vcc, 0, v244
    s_nop 4
    s_cbranch_vccnz SLOW_67
RET_68:
    ds_read_b64_tr_b16 v[176:177], v248 offset:49152
    ds_read_b64_tr_b16 v[178:179], v248 offset:49664
    ds_read_b64_tr_b16 v[180:181], v249 offset:49152
    ds_read_b64_tr_b16 v[182:183], v249 offset:49664
    s_waitcnt lgkmcnt(15)
    v_mfma_f32_32x32x16_bf16 v[128:143], v[196:199], v[88:91], v[128:143]
    ds_read_b64_tr_b16 v[184:185], v248 offset:57344
    ds_read_b64_tr_b16 v[186:187], v248 offset:57856
    ds_read_b64_tr_b16 v[188:189], v249 offset:57344
    ds_read_b64_tr_b16 v[190:191], v249 offset:57856
    v_add_u32 v224, 32768, v224
    s_waitcnt lgkmcnt(15)
    v_mfma_f32_32x32x16_bf16 v[144:159], v[200:203], v[88:91], v[144:159]
    v_add_u32 v225, 32768, v225
    v_add_u32 v226, 32768, v226
    v_add_u32 v227, 32768, v227
    ds_read_b128 v[96:99], v224
    ds_read_b128 v[100:103], v225
    v_mfma_f32_32x32x16_bf16 v[160:175], v[204:207], v[88:91], v[160:175]
    ds_read_b128 v[104:107], v226
    ds_read_b128 v[108:111], v227
    s_waitcnt lgkmcnt(15)
    v_mfma_f32_32x32x16_bf16 v[112:127], v[208:211], v[92:95], v[112:127]
    ds_read_b64_tr_b16 v[192:193], v248 offset:51200
    ds_read_b64_tr_b16 v[194:195], v248 offset:51712
    ds_read_b64_tr_b16 v[196:197], v249 offset:51200
    v_mfma_f32_32x32x16_bf16 v[128:143], v[212:215], v[92:95], v[128:143]
    ds_read_b64_tr_b16 v[198:199], v249 offset:51712
    ds_read_b64_tr_b16 v[200:201], v248 offset:59392
    ds_read_b64_tr_b16 v[202:203], v248 offset:59904
    s_waitcnt lgkmcnt(15)
    v_mfma_f32_32x32x16_bf16 v[144:159], v[216:219], v[92:95], v[144:159]
    ds_read_b64_tr_b16 v[204:205], v249 offset:59392
    ds_read_b64_tr_b16 v[206:207], v249 offset:59904
    s_waitcnt lgkmcnt(8)
    s_add_u32 m0, s46, 544
    s_mov_b64 exec, 1
    buffer_load_dword v255, s[36:39], 0 offen lds
    s_mov_b64 exec, -1
    v_mfma_f32_32x32x16_bf16 v[160:175], v[220:223], v[92:95], v[160:175]
    v_dot2c_f32_bf16 v241, s53, v96
    v_dot2c_f32_bf16 v243, v96, v96
    v_dot2c_f32_bf16 v242, s53, v97
    v_dot2c_f32_bf16 v254, v97, v97
    v_dot2c_f32_bf16 v241, s53, v98
    v_dot2c_f32_bf16 v243, v98, v98
    v_dot2c_f32_bf16 v242, s53, v99
    v_dot2c_f32_bf16 v254, v99, v99
    v_dot2c_f32_bf16 v241, s53, v100
    v_dot2c_f32_bf16 v243, v100, v100
    v_dot2c_f32_bf16 v242, s53, v101
    v_dot2c_f32_bf16 v254, v101, v101
    v_dot2c_f32_bf16 v241, s53, v102
    v_dot2c_f32_bf16 v243, v102, v102
    v_dot2c_f32_bf16 v242, s53, v103
    v_dot2c_f32_bf16 v254, v103, v103
    v_dot2c_f32_bf16 v241, s53, v104
    v_dot2c_f32_bf16 v243, v104, v104
    v_dot2c_f32_bf16 v242, s53, v105
    v_dot2c_f32_bf16 v254, v105, v105
    v_dot2c_f32_bf16 v241, s53, v106
    v_dot2c_f32_bf16 v243, v106, v106
    v_dot2c_f32_bf16 v242, s53, v107
    v_dot2c_f32_bf16 v254, v107, v107
    v_dot2c_f32_bf16 v241, s53, v108
    v_dot2c_f32_bf16 v243, v108, v108
    v_dot2c_f32_bf16 v242, s53, v109
    v_dot2c_f32_bf16 v254, v109, v109
    v_dot2c_f32_bf16 v241, s53, v110
    v_dot2c_f32_bf16 v243, v110, v110
    v_dot2c_f32_bf16 v242, s53, v111
    v_dot2c_f32_bf16 v254, v111, v111
    v_mov_b32 v234, 0
    buffer_load_dwordx2 v[232:233], v234, s[36:39], 0 offen sc1
    v_mfma_f32_32x32x16_bf16 v[112:127], v[176:179], v[96:99], v[112:127]
    ds_read_b128 v[244:247], v255 offset:624
    ds_read_b64_tr_b16 v[208:209], v248 offset:53248
    ds_read_b64_tr_b16 v[210:211], v248 offset:53760
    ds_read_b64_tr_b16 v[212:213], v249 offset:53248
    ds_read_b64_tr_b16 v[214:215], v249 offset:53760
    v_mfma_f32_32x32x16_bf16 v[128:143], v[180:183], v[96:99], v[128:143]
    ds_read_b64_tr_b16 v[216:217], v248 offset:61440
    ds_read_b64_tr_b16 v[218:219], v248 offset:61952
    ds_read_b64_tr_b16 v[220:221], v249 offset:61440
    ds_read_b64_tr_b16 v[222:223], v249 offset:61952
    v_add_f32 v241, v241, v242
    v_mfma_f32_32x32x16_bf16 v[144:159], v[184:187], v[96:99], v[144:159]
    v_add_f32 v243, v243, v254
    v_mov_b32 v242, v241
    v_mov_b32 v254, v243
    s_nop 0
    v_permlane32_swap_b32 v241, v242
    v_permlane32_swap_b32 v243, v254
    v_mfma_f32_32x32x16_bf16 v[160:175], v[188:191], v[96:99], v[160:175]
    v_add_f32 v241, v241, v242
    v_add_f32 v243, v243, v254
    s_waitcnt lgkmcnt(15)
    v_mfma_f32_32x32x16_bf16 v[112:127], v[192:195], v[100:103], v[112:127]
    s_waitcnt lgkmcnt(8)
    v_or3_b32 v244, v244, v245, v246
    v_or_b32 v244, v244, v247
    v_cmp_ne_u32 vcc, 0, v244
    s_nop 4
    s_cbranch_vccnz SLOW_69
RET_70:
    ds_read_b128 v[244:247], v255 offset:640
    ds_read_b64_tr_b16 v[176:177], v248 offset:55296
    ds_read_b64_tr_b16 v[178:179], v248 offset:55808
    ds_read_b64_tr_b16 v[180:181], v249 offset:55296
    v_mfma_f32_32x32x16_bf16 v[128:143], v[196:199], v[100:103], v[128:143]
    ds_read_b64_tr_b16 v[182:183], v249 offset:55808
    ds_read_b64_tr_b16 v[184:185], v248 offset:63488
    ds_read_b64_tr_b16 v[186:187], v248 offset:64000
    ds_read_b64_tr_b16 v[188:189], v249 offset:63488
    ds_read_b64_tr_b16 v[190:191], v249 offset:64000
    v_mfma_f32_32x32x16_bf16 v[144:159], v[200:203], v[100:103], v[144:159]
    v_mul_f32 v241, 0x3b124925, v241
    v_mul_f32 v243, 0x3b124925, v243
    v_fma_f32 v243, -v241, v241, v243
    v_max_f32 v243, 0, v243
    v_cvt_pk_bf16_f32 v242, v243, v243
    v_mfma_f32_32x32x16_bf16 v[160:175], v[204:207], v[100:103], v[160:175]
    v_and_b32 v243, 0xffff0000, v242
    v_add_f32 v243, 0x3727c5ac, v243
    v_cvt_pk_bf16_f32 v243, v243, v243
    s_waitcnt lgkmcnt(15)
    v_mfma_f32_32x32x16_bf16 v[112:127], v[208:211], v[104:107], v[112:127]
    s_waitcnt lgkmcnt(8)
    v_or3_b32 v244, v244, v245, v246
    v_or_b32 v244, v244, v247
    v_cmp_ne_u32 vcc, 0, v244
    s_nop 4
    s_cbranch_vccnz SLOW_71
RET_72:
    ds_read_b128 v[192:195], v253 offset:0
    ds_read_b128 v[196:199], v253 offset:1024
    ds_read_b128 v[200:203], v253 offset:2048
    v_mfma_f32_32x32x16_bf16 v[128:143], v[212:215], v[104:107], v[128:143]
    ds_read_b128 v[204:207], v253 offset:3072
    v_and_b32 v243, 0xffff0000, v243
    v_sqrt_f32 v243, v243
    v_cvt_pk_bf16_f32 v236, -v241, -v241
    v_mfma_f32_32x32x16_bf16 v[144:159], v[216:219], v[104:107], v[144:159]
    v_cvt_pk_bf16_f32 v237, -v241, v243
    v_and_b32 v243, 0xffff0000, v237
    v_rcp_f32 v235, v243
    v_mov_b32 v238, v236
    v_mfma_f32_32x32x16_bf16 v[160:175], v[220:223], v[104:107], v[160:175]
    v_mov_b32 v239, v237
    ds_read_b128 v[244:247], v255 offset:112
    s_waitcnt lgkmcnt(11)
    v_mfma_f32_32x32x16_bf16 v[112:127], v[176:179], v[108:111], v[112:127]
    s_waitcnt lgkmcnt(0)
    v_or3_b32 v244, v244, v245, v246
    v_or_b32 v244, v244, v247
    v_cmp_ne_u32 vcc, 0, v244
    s_nop 4
    s_cbranch_vccnz SLOW_73
RET_74:
    ds_read_b64_tr_b16 v[224:225], v250 offset:16384
    v_mfma_f32_32x32x16_bf16 v[128:143], v[180:183], v[108:111], v[128:143]
    ds_read_b64_tr_b16 v[226:227], v250 offset:16896
    s_waitcnt vmcnt(8)
    ds_read_b64_tr_b16 v[228:229], v251 offset:16384
    v_mfma_f32_32x32x16_bf16 v[144:159], v[184:187], v[108:111], v[144:159]
    ds_read_b64_tr_b16 v[230:231], v251 offset:16896
    v_mfma_f32_32x32x16_bf16 v[160:175], v[188:191], v[108:111], v[160:175]
    v_mfma_f32_32x32x16_bf16 v[112:127], v[192:195], v[236:239], v[112:127]
    ds_read_b64_tr_b16 v[208:209], v250 offset:18432
    ds_read_b64_tr_b16 v[210:211], v250 offset:18944
    v_mfma_f32_32x32x16_bf16 v[128:143], v[196:199], v[236:239], v[128:143]
    ds_read_b64_tr_b16 v[212:213], v251 offset:18432
    ds_read_b64_tr_b16 v[214:215], v251 offset:18944
    v_mfma_f32_32x32x16_bf16 v[144:159], v[200:203], v[236:239], v[144:159]
    ds_read_b128 v[244:247], v255 offset:128
    v_mfma_f32_32x32x16_bf16 v[160:175], v[204:207], v[236:239], v[160:175]
    s_setprio 2
    s_add_u32 m0, s46, 560
    s_mov_b64 exec, 1
    buffer_load_dword v255, s[36:39], 0 offen lds
    s_mov_b64 exec, -1
    s_mov_b32 s43, 0
    s_mov_b32 s45, 0
    s_waitcnt lgkmcnt(7)
    v_mfma_f32_32x32x16_bf16 v[176:191], v[224:227], v[0:3], 0
    ds_read_b64_tr_b16 v[216:217], v250 offset:20480
    ds_read_b64_tr_b16 v[218:219], v250 offset:20992
    ds_read_b64_tr_b16 v[220:221], v251 offset:20480
    ds_read_b64_tr_b16 v[222:223], v251 offset:20992
    s_add_u32 s56, s44, 0
    s_lshl_b32 s54, s56, 12
    s_add_u32 s54, s54, s100
    s_lshl_b32 s48, s56, 7
    s_add_u32 s48, s48, s101
    s_cmp_ge_u32 s56, 21
    s_cselect_b32 s57, 0, 0xff7fffff
    s_cselect_b32 s58, 1.0, 0
    s_cselect_b32 s59, 0, 1.0
    s_waitcnt lgkmcnt(9)
    v_mfma_f32_32x32x16_bf16 v[192:207], v[228:231], v[0:3], 0
    s_cmp_lt_u32 s56, 7
    s_cselect_b32 s59, 0x3e8b97f6, s59
    v_mul_f32 v241, v235, v235
    v_mul_f32 v241, s58, v241
    v_mul_f32 v242, s59, v235
    v_mul_f32 v112, v112, v242
    v_mul_f32 v113, v113, v242
    v_cvt_pk_bf16_f32 v112, v112, v113
    v_mul_f32 v114, v114, v242
    s_waitcnt lgkmcnt(7)
    v_mfma_f32_32x32x16_bf16 v[176:191], v[208:211], v[4:7], v[176:191]
    ds_read_b64_tr_b16 v[224:225], v250 offset:22528
    ds_read_b64_tr_b16 v[226:227], v250 offset:23040
    ds_read_b64_tr_b16 v[228:229], v251 offset:22528
    ds_read_b64_tr_b16 v[230:231], v251 offset:23040
    v_mul_f32 v115, v115, v242
    v_cvt_pk_bf16_f32 v113, v114, v115
    v_mul_f32 v116, v116, v242
    v_mul_f32 v117, v117, v242
    v_cvt_pk_bf16_f32 v114, v116, v117
    v_mul_f32 v118, v118, v242
    v_mul_f32 v119, v119, v242
    v_cvt_pk_bf16_f32 v115, v118, v119
    buffer_store_dwordx4 v[112:115], v252, s[16:19], s54 offen offset:0 sc1
    v_mul_f32 v120, v120, v242
    v_mul_f32 v121, v121, v242
    v_cvt_pk_bf16_f32 v120, v120, v121
    s_waitcnt lgkmcnt(9)
    v_mfma_f32_32x32x16_bf16 v[192:207], v[212:215], v[4:7], v[192:207]
    v_mul_f32 v122, v122, v242
    v_mul_f32 v123, v123, v242
    v_cvt_pk_bf16_f32 v121, v122, v123
    v_mul_f32 v124, v124, v242
    v_mul_f32 v125, v125, v242
    v_cvt_pk_bf16_f32 v122, v124, v125
    v_mul_f32 v126, v126, v242
    v_mul_f32 v127, v127, v242
    v_cvt_pk_bf16_f32 v123, v126, v127
    buffer_store_dwordx4 v[120:123], v252, s[16:19], s54 offen offset:1024 sc1
    v_mul_f32 v128, v128, v242
    v_mul_f32 v129, v129, v242
    s_waitcnt lgkmcnt(6)
    v_mfma_f32_32x32x16_bf16 v[176:191], v[216:219], v[8:11], v[176:191]
    v_or3_b32 v244, v244, v245, v246
    v_or_b32 v244, v244, v247
    v_cmp_ne_u32 vcc, 0, v244
    s_nop 4
    s_cbranch_vccnz SLOW_75
RET_76:
    ds_read_b64_tr_b16 v[208:209], v250 offset:24576
    ds_read_b64_tr_b16 v[210:211], v250 offset:25088
    ds_read_b64_tr_b16 v[212:213], v251 offset:24576
    ds_read_b64_tr_b16 v[214:215], v251 offset:25088
    v_cvt_pk_bf16_f32 v128, v128, v129
    v_mul_f32 v130, v130, v242
    v_mul_f32 v131, v131, v242
    v_cvt_pk_bf16_f32 v129, v130, v131
    v_mul_f32 v132, v132, v242
    v_mul_f32 v133, v133, v242
    v_cvt_pk_bf16_f32 v130, v132, v133
    v_mul_f32 v134, v134, v242
    v_mul_f32 v135, v135, v242
    v_cvt_pk_bf16_f32 v131, v134, v135
    buffer_store_dwordx4 v[128:131], v252, s[16:19], s54 offen offset:2048 sc1
    v_mul_f32 v136, v136, v242
    s_waitcnt lgkmcnt(8)
    v_mfma_f32_32x32x16_bf16 v[192:207], v[220:223], v[8:11], v[192:207]
    v_mul_f32 v137, v137, v242
    v_cvt_pk_bf16_f32 v136, v136, v137
    v_mul_f32 v138, v138, v242
    v_mul_f32 v139, v139, v242
    v_cvt_pk_bf16_f32 v137, v138, v139
    v_mul_f32 v140, v140, v242
    v_mul_f32 v141, v141, v242
    v_cvt_pk_bf16_f32 v138, v140, v141
    v_mul_f32 v142, v142, v242
    v_mul_f32 v143, v143, v242
    v_cvt_pk_bf16_f32 v139, v142, v143
    buffer_store_dwordx4 v[136:139], v252, s[16:19], s54 offen offset:3072 sc1
    s_waitcnt lgkmcnt(6)
    v_mfma_f32_32x32x16_bf16 v[176:191], v[224:227], v[12:15], v[176:191]
    ds_read_b64_tr_b16 v[216:217], v250 offset:26624
    ds_read_b64_tr_b16 v[218:219], v250 offset:27136
    ds_read_b64_tr_b16 v[220:221], v251 offset:26624
    ds_read_b64_tr_b16 v[222:223], v251 offset:27136
    s_waitcnt vmcnt(5)
    v_readfirstlane_b32 s60, v232
    v_readfirstlane_b32 s61, v233
    s_cmp_lg_u32 s60, 0
    s_cbranch_scc0 SLOW_77
RET_78:
    s_add_u32 s56, s44, 16
    s_lshl_b32 s54, s56, 12
    s_add_u32 s54, s54, s100
    s_lshl_b32 s49, s56, 7
    s_add_u32 s49, s49, s101
    s_cmp_ge_u32 s56, 21
    s_cselect_b32 s57, 0, 0xff7fffff
    s_cselect_b32 s58, 1.0, 0
    s_cselect_b32 s59, 0, 1.0
    s_cmp_lt_u32 s56, 7
    s_cselect_b32 s59, 0x3e8b97f6, s59
    s_waitcnt lgkmcnt(8)
    v_mfma_f32_32x32x16_bf16 v[192:207], v[228:231], v[12:15], v[192:207]
    v_mul_f32 v241, v235, v235
    v_mul_f32 v241, s58, v241
    v_mul_f32 v242, s59, v235
    v_max_f32 v144, s57, v144
    v_max_f32 v145, s57, v145
    v_fma_f32 v243, v144, v241, v242
    v_fma_f32 v254, v145, v241, v242
    v_mul_f32 v243, v144, v243
    v_mul_f32 v254, v145, v254
    v_cvt_pk_bf16_f32 v144, v243, v254
    v_max_f32 v146, s57, v146
    v_max_f32 v147, s57, v147
    s_waitcnt lgkmcnt(6)
    v_mfma_f32_32x32x16_bf16 v[176:191], v[208:211], v[16:19], v[176:191]
    ds_read_b64_tr_b16 v[224:225], v250 offset:28672
    ds_read_b64_tr_b16 v[226:227], v250 offset:29184
    ds_read_b64_tr_b16 v[228:229], v251 offset:28672
    ds_read_b64_tr_b16 v[230:231], v251 offset:29184
    ds_read_b128 v[244:247], v255 offset:160
    v_fma_f32 v243, v146, v241, v242
    v_fma_f32 v254, v147, v241, v242
    v_mul_f32 v243, v146, v243
    v_mul_f32 v254, v147, v254
    v_cvt_pk_bf16_f32 v145, v243, v254
    v_max_f32 v148, s57, v148
    v_max_f32 v149, s57, v149
    v_fma_f32 v243, v148, v241, v242
    v_fma_f32 v254, v149, v241, v242
    v_mul_f32 v243, v148, v243
    v_mul_f32 v254, v149, v254
    v_cvt_pk_bf16_f32 v146, v243, v254
    s_waitcnt lgkmcnt(9)
    v_mfma_f32_32x32x16_bf16 v[192:207], v[212:215], v[16:19], v[192:207]
    v_max_f32 v150, s57, v150
    v_max_f32 v151, s57, v151
    v_fma_f32 v243, v150, v241, v242
    v_fma_f32 v254, v151, v241, v242
    v_mul_f32 v243, v150, v243
    v_mul_f32 v254, v151, v254
    v_cvt_pk_bf16_f32 v147, v243, v254
    buffer_store_dwordx4 v[144:147], v252, s[16:19], s54 offen offset:0 sc1
    v_max_f32 v152, s57, v152
    v_max_f32 v153, s57, v153
    v_fma_f32 v243, v152, v241, v242
    v_fma_f32 v254, v153, v241, v242
    s_waitcnt lgkmcnt(7)
    v_mfma_f32_32x32x16_bf16 v[176:191], v[216:219], v[20:23], v[176:191]
    ds_read_b64_tr_b16 v[208:209], v250 offset:30720
    ds_read_b64_tr_b16 v[210:211], v250 offset:31232
    ds_read_b64_tr_b16 v[212:213], v251 offset:30720
    ds_read_b64_tr_b16 v[214:215], v251 offset:31232
    v_mul_f32 v243, v152, v243
    v_mul_f32 v254, v153, v254
    v_cvt_pk_bf16_f32 v152, v243, v254
    v_max_f32 v154, s57, v154
    v_max_f32 v155, s57, v155
    v_fma_f32 v243, v154, v241, v242
    v_fma_f32 v254, v155, v241, v242
    v_mul_f32 v243, v154, v243
    v_mul_f32 v254, v155, v254
    v_cvt_pk_bf16_f32 v153, v243, v254
    v_max_f32 v156, s57, v156
    v_max_f32 v157, s57, v157
    s_waitcnt lgkmcnt(9)
    v_mfma_f32_32x32x16_bf16 v[192:207], v[220:223], v[20:23], v[192:207]
    v_fma_f32 v243, v156, v241, v242
    v_fma_f32 v254, v157, v241, v242
    v_mul_f32 v243, v156, v243
    v_mul_f32 v254, v157, v254
    v_cvt_pk_bf16_f32 v154, v243, v254
    v_max_f32 v158, s57, v158
    v_max_f32 v159, s57, v159
    v_fma_f32 v243, v158, v241, v242
    v_fma_f32 v254, v159, v241, v242
    v_mul_f32 v243, v158, v243
    v_mul_f32 v254, v159, v254
    v_cvt_pk_bf16_f32 v155, v243, v254
    s_waitcnt lgkmcnt(7)
    v_mfma_f32_32x32x16_bf16 v[176:191], v[224:227], v[24:27], v[176:191]
    s_waitcnt lgkmcnt(4)
    v_or3_b32 v244, v244, v245, v246
    v_or_b32 v244, v244, v247
    v_cmp_ne_u32 vcc, 0, v244
    s_nop 4
    s_cbranch_vccnz SLOW_79
RET_80:
    ds_read_b64_tr_b16 v[216:217], v250 offset:0
    ds_read_b64_tr_b16 v[218:219], v250 offset:512
    ds_read_b64_tr_b16 v[220:221], v251 offset:0
    ds_read_b64_tr_b16 v[222:223], v251 offset:512
    buffer_store_dwordx4 v[152:155], v252, s[16:19], s54 offen offset:1024 sc1
    v_max_f32 v160, s57, v160
    v_max_f32 v161, s57, v161
    v_fma_f32 v243, v160, v241, v242
    v_fma_f32 v254, v161, v241, v242
    v_mul_f32 v243, v160, v243
    v_mul_f32 v254, v161, v254
    v_cvt_pk_bf16_f32 v160, v243, v254
    v_max_f32 v162, s57, v162
    v_max_f32 v163, s57, v163
    v_fma_f32 v243, v162, v241, v242
    v_fma_f32 v254, v163, v241, v242
    v_mfma_f32_32x32x16_bf16 v[192:207], v[228:231], v[24:27], v[192:207]
    v_mul_f32 v243, v162, v243
    v_mul_f32 v254, v163, v254
    v_cvt_pk_bf16_f32 v161, v243, v254
    v_max_f32 v164, s57, v164
    v_max_f32 v165, s57, v165
    v_fma_f32 v243, v164, v241, v242
    v_fma_f32 v254, v165, v241, v242
    v_mul_f32 v243, v164, v243
    v_mul_f32 v254, v165, v254
    v_cvt_pk_bf16_f32 v162, v243, v254
    v_max_f32 v166, s57, v166
    v_max_f32 v167, s57, v167
    s_waitcnt lgkmcnt(6)
    v_mfma_f32_32x32x16_bf16 v[176:191], v[208:211], v[28:31], v[176:191]
    ds_read_b64_tr_b16 v[224:225], v250 offset:2048
    ds_read_b64_tr_b16 v[226:227], v250 offset:2560
    ds_read_b64_tr_b16 v[228:229], v251 offset:2048
    ds_read_b64_tr_b16 v[230:231], v251 offset:2560
    v_fma_f32 v243, v166, v241, v242
    v_fma_f32 v254, v167, v241, v242
    v_mul_f32 v243, v166, v243
    v_mul_f32 v254, v167, v254
    v_cvt_pk_bf16_f32 v163, v243, v254
    buffer_store_dwordx4 v[160:163], v252, s[16:19], s54 offen offset:2048 sc1
    v_max_f32 v168, s57, v168
    v_max_f32 v169, s57, v169
    v_fma_f32 v243, v168, v241, v242
    v_fma_f32 v254, v169, v241, v242
    v_mul_f32 v243, v168, v243
    v_mul_f32 v254, v169, v254
    s_waitcnt lgkmcnt(8)
    v_mfma_f32_32x32x16_bf16 v[192:207], v[212:215], v[28:31], v[192:207]
    v_cvt_pk_bf16_f32 v168, v243, v254
    v_max_f32 v170, s57, v170
    v_max_f32 v171, s57, v171
    v_fma_f32 v243, v170, v241, v242
    v_fma_f32 v254, v171, v241, v242
    v_mul_f32 v243, v170, v243
    v_mul_f32 v254, v171, v254
    v_cvt_pk_bf16_f32 v169, v243, v254
    v_max_f32 v172, s57, v172
    v_max_f32 v173, s57, v173
    v_fma_f32 v243, v172, v241, v242
    v_fma_f32 v254, v173, v241, v242
    s_waitcnt lgkmcnt(6)
    v_mfma_f32_32x32x16_bf16 v[176:191], v[216:219], v[32:35], v[176:191]
    ds_read_b64_tr_b16 v[208:209], v250 offset:4096
    ds_read_b64_tr_b16 v[210:211], v250 offset:4608
    ds_read_b64_tr_b16 v[212:213], v251 offset:4096
    ds_read_b64_tr_b16 v[214:215], v251 offset:4608
    v_mul_f32 v243, v172, v243
    v_mul_f32 v254, v173, v254
    v_cvt_pk_bf16_f32 v170, v243, v254
    v_max_f32 v174, s57, v174
    v_max_f32 v175, s57, v175
    v_fma_f32 v243, v174, v241, v242
    v_fma_f32 v254, v175, v241, v242
    v_mul_f32 v243, v174, v243
    v_mul_f32 v254, v175, v254
    v_cvt_pk_bf16_f32 v171, v243, v254
    buffer_store_dwordx4 v[168:171], v252, s[16:19], s54 offen offset:3072 sc1
    s_waitcnt lgkmcnt(8)
    v_mfma_f32_32x32x16_bf16 v[192:207], v[220:223], v[32:35], v[192:207]
    s_waitcnt lgkmcnt(6)
    v_mfma_f32_32x32x16_bf16 v[176:191], v[224:227], v[36:39], v[176:191]
    ds_read_b64_tr_b16 v[216:217], v250 offset:6144
    ds_read_b64_tr_b16 v[218:219], v250 offset:6656
    ds_read_b64_tr_b16 v[220:221], v251 offset:6144
    ds_read_b64_tr_b16 v[222:223], v251 offset:6656
    s_waitcnt lgkmcnt(8)
    v_mfma_f32_32x32x16_bf16 v[192:207], v[228:231], v[36:39], v[192:207]
    s_waitcnt lgkmcnt(6)
    v_mfma_f32_32x32x16_bf16 v[176:191], v[208:211], v[40:43], v[176:191]
    ds_read_b64_tr_b16 v[224:225], v250 offset:8192
    ds_read_b64_tr_b16 v[226:227], v250 offset:8704
    ds_read_b64_tr_b16 v[228:229], v251 offset:8192
    ds_read_b64_tr_b16 v[230:231], v251 offset:8704
    s_waitcnt lgkmcnt(8)
    v_mfma_f32_32x32x16_bf16 v[192:207], v[212:215], v[40:43], v[192:207]
    s_waitcnt lgkmcnt(6)
    v_mfma_f32_32x32x16_bf16 v[176:191], v[216:219], v[44:47], v[176:191]
    ds_read_b64_tr_b16 v[208:209], v250 offset:10240
    ds_read_b64_tr_b16 v[210:211], v250 offset:10752
    ds_read_b64_tr_b16 v[212:213], v251 offset:10240
    ds_read_b64_tr_b16 v[214:215], v251 offset:10752
    s_waitcnt lgkmcnt(8)
    v_mfma_f32_32x32x16_bf16 v[192:207], v[220:223], v[44:47], v[192:207]
    s_waitcnt lgkmcnt(6)
    v_mfma_f32_32x32x16_bf16 v[176:191], v[224:227], v[48:51], v[176:191]
    ds_read_b64_tr_b16 v[216:217], v250 offset:12288
    ds_read_b64_tr_b16 v[218:219], v250 offset:12800
    ds_read_b64_tr_b16 v[220:221], v251 offset:12288
    ds_read_b64_tr_b16 v[222:223], v251 offset:12800
    ds_read_b128 v[244:247], v255 offset:192
    s_waitcnt lgkmcnt(9)
    v_mfma_f32_32x32x16_bf16 v[192:207], v[228:231], v[48:51], v[192:207]
    s_waitcnt vmcnt(4)
    v_mov_b32 v232, s60
    v_mov_b32 v233, s61
    v_lshlrev_b32 v234, 3, v240
    s_mov_b64 exec, 0xffff
    buffer_store_dwordx2 v[232:233], v234, s[16:19], s48 offen sc1
    s_mov_b64 exec, -1
    s_waitcnt lgkmcnt(7)
    v_mfma_f32_32x32x16_bf16 v[176:191], v[208:211], v[52:55], v[176:191]
    ds_read_b64_tr_b16 v[224:225], v250 offset:14336
    ds_read_b64_tr_b16 v[226:227], v250 offset:14848
    ds_read_b64_tr_b16 v[228:229], v251 offset:14336
    ds_read_b64_tr_b16 v[230:231], v251 offset:14848
    s_waitcnt lgkmcnt(9)
    v_mfma_f32_32x32x16_bf16 v[192:207], v[212:215], v[52:55], v[192:207]
    s_waitcnt lgkmcnt(7)
    v_mfma_f32_32x32x16_bf16 v[176:191], v[216:219], v[56:59], v[176:191]
    s_waitcnt lgkmcnt(4)
    v_or3_b32 v244, v244, v245, v246
    v_or_b32 v244, v244, v247
    v_cmp_ne_u32 vcc, 0, v244
    s_nop 4
    s_cbranch_vccnz SLOW_81
RET_82:
    ds_read_b64_tr_b16 v[208:209], v250 offset:49152
    ds_read_b64_tr_b16 v[210:211], v250 offset:49664
    ds_read_b64_tr_b16 v[212:213], v251 offset:49152
    ds_read_b64_tr_b16 v[214:215], v251 offset:49664
    v_mfma_f32_32x32x16_bf16 v[192:207], v[220:223], v[56:59], v[192:207]
    s_waitcnt lgkmcnt(6)
    v_mfma_f32_32x32x16_bf16 v[176:191], v[224:227], v[60:63], v[176:191]
    ds_read_b64_tr_b16 v[216:217], v250 offset:51200
    ds_read_b64_tr_b16 v[218:219], v250 offset:51712
    ds_read_b64_tr_b16 v[220:221], v251 offset:51200
    ds_read_b64_tr_b16 v[222:223], v251 offset:51712
    s_waitcnt lgkmcnt(8)
    v_mfma_f32_32x32x16_bf16 v[192:207], v[228:231], v[60:63], v[192:207]
    s_waitcnt lgkmcnt(6)
    v_mfma_f32_32x32x16_bf16 v[176:191], v[208:211], v[64:67], v[176:191]
    ds_read_b64_tr_b16 v[224:225], v250 offset:53248
    ds_read_b64_tr_b16 v[226:227], v250 offset:53760
    ds_read_b64_tr_b16 v[228:229], v251 offset:53248
    ds_read_b64_tr_b16 v[230:231], v251 offset:53760
    s_waitcnt lgkmcnt(8)
    v_mfma_f32_32x32x16_bf16 v[192:207], v[212:215], v[64:67], v[192:207]
    s_waitcnt lgkmcnt(6)
    v_mfma_f32_32x32x16_bf16 v[176:191], v[216:219], v[68:71], v[176:191]
    ds_read_b64_tr_b16 v[208:209], v250 offset:55296
    ds_read_b64_tr_b16 v[210:211], v250 offset:55808
    ds_read_b64_tr_b16 v[212:213], v251 offset:55296
    ds_read_b64_tr_b16 v[214:215], v251 offset:55808
    s_waitcnt lgkmcnt(8)
    v_mfma_f32_32x32x16_bf16 v[192:207], v[220:223], v[68:71], v[192:207]
    s_waitcnt lgkmcnt(6)
    v_mfma_f32_32x32x16_bf16 v[176:191], v[224:227], v[72:75], v[176:191]
    ds_read_b64_tr_b16 v[216:217], v250 offset:57344
    ds_read_b64_tr_b16 v[218:219], v250 offset:57856
    ds_read_b64_tr_b16 v[220:221], v251 offset:57344
    ds_read_b64_tr_b16 v[222:223], v251 offset:57856
    s_waitcnt lgkmcnt(8)
    v_mfma_f32_32x32x16_bf16 v[192:207], v[228:231], v[72:75], v[192:207]
    s_waitcnt lgkmcnt(6)
    v_mfma_f32_32x32x16_bf16 v[176:191], v[208:211], v[76:79], v[176:191]
    ds_read_b64_tr_b16 v[224:225], v250 offset:59392
    ds_read_b64_tr_b16 v[226:227], v250 offset:59904
    ds_read_b64_tr_b16 v[228:229], v251 offset:59392
    ds_read_b64_tr_b16 v[230:231], v251 offset:59904
    s_waitcnt lgkmcnt(8)
    v_mfma_f32_32x32x16_bf16 v[192:207], v[212:215], v[76:79], v[192:207]
    s_waitcnt lgkmcnt(6)
    v_mfma_f32_32x32x16_bf16 v[176:191], v[216:219], v[80:83], v[176:191]
    ds_read_b64_tr_b16 v[208:209], v250 offset:61440
    ds_read_b64_tr_b16 v[210:211], v250 offset:61952
    ds_read_b64_tr_b16 v[212:213], v251 offset:61440
    ds_read_b64_tr_b16 v[214:215], v251 offset:61952
    ds_read_b128 v[244:247], v255 offset:208
    s_waitcnt lgkmcnt(9)
    v_mfma_f32_32x32x16_bf16 v[192:207], v[220:223], v[80:83], v[192:207]
    s_waitcnt lgkmcnt(7)
    v_mfma_f32_32x32x16_bf16 v[176:191], v[224:227], v[84:87], v[176:191]
    ds_read_b64_tr_b16 v[216:217], v250 offset:63488
    ds_read_b64_tr_b16 v[218:219], v250 offset:64000
    ds_read_b64_tr_b16 v[220:221], v251 offset:63488
    ds_read_b64_tr_b16 v[222:223], v251 offset:64000
    s_waitcnt lgkmcnt(9)
    v_mfma_f32_32x32x16_bf16 v[192:207], v[228:231], v[84:87], v[192:207]
    s_waitcnt lgkmcnt(7)
    v_mfma_f32_32x32x16_bf16 v[176:191], v[208:211], v[88:91], v[176:191]
    s_waitcnt lgkmcnt(4)
    v_or3_b32 v244, v244, v245, v246
    v_or_b32 v244, v244, v247
    v_cmp_ne_u32 vcc, 0, v244
    s_nop 4
    s_cbranch_vccnz SLOW_83
RET_84:
    ds_read_b64_tr_b16 v[224:225], v250 offset:32768
    ds_read_b64_tr_b16 v[226:227], v250 offset:33280
    ds_read_b64_tr_b16 v[228:229], v251 offset:32768
    ds_read_b64_tr_b16 v[230:231], v251 offset:33280
    v_mfma_f32_32x32x16_bf16 v[192:207], v[212:215], v[88:91], v[192:207]
    s_waitcnt vmcnt(1)
    v_mov_b32 v232, s60
    v_mov_b32 v233, s61
    v_lshlrev_b32 v234, 3, v240
    s_mov_b64 exec, 0xffff
    buffer_store_dwordx2 v[232:233], v234, s[16:19], s49 offen sc1
    s_mov_b64 exec, -1
    s_waitcnt lgkmcnt(6)
    v_mfma_f32_32x32x16_bf16 v[176:191], v[216:219], v[92:95], v[176:191]
    ds_read_b64_tr_b16 v[208:209], v250 offset:34816
    ds_read_b64_tr_b16 v[210:211], v250 offset:35328
    ds_read_b64_tr_b16 v[212:213], v251 offset:34816
    ds_read_b64_tr_b16 v[214:215], v251 offset:35328
    s_waitcnt lgkmcnt(8)
    v_mfma_f32_32x32x16_bf16 v[192:207], v[220:223], v[92:95], v[192:207]
    s_waitcnt lgkmcnt(6)
    v_mfma_f32_32x32x16_bf16 v[176:191], v[224:227], v[96:99], v[176:191]
    ds_read_b64_tr_b16 v[216:217], v250 offset:36864
    ds_read_b64_tr_b16 v[218:219], v250 offset:37376
    ds_read_b64_tr_b16 v[220:221], v251 offset:36864
    ds_read_b64_tr_b16 v[222:223], v251 offset:37376
    ds_read_b128 v[244:247], v255 offset:656
    s_waitcnt lgkmcnt(9)
    v_mfma_f32_32x32x16_bf16 v[192:207], v[228:231], v[96:99], v[192:207]
    s_waitcnt lgkmcnt(7)
    v_mfma_f32_32x32x16_bf16 v[176:191], v[208:211], v[100:103], v[176:191]
    ds_read_b64_tr_b16 v[224:225], v250 offset:38912
    ds_read_b64_tr_b16 v[226:227], v250 offset:39424
    ds_read_b64_tr_b16 v[228:229], v251 offset:38912
    ds_read_b64_tr_b16 v[230:231], v251 offset:39424
    s_waitcnt lgkmcnt(9)
    v_mfma_f32_32x32x16_bf16 v[192:207], v[212:215], v[100:103], v[192:207]
    s_waitcnt lgkmcnt(7)
    v_mfma_f32_32x32x16_bf16 v[176:191], v[216:219], v[104:107], v[176:191]
    s_waitcnt lgkmcnt(4)
    v_or3_b32 v244, v244, v245, v246
    v_or_b32 v244, v244, v247
    v_cmp_ne_u32 vcc, 0, v244
    s_nop 4
    s_cbranch_vccnz SLOW_85
RET_86:
    ds_read_b128 v[208:211], v253 offset:4096
    ds_read_b128 v[212:215], v253 offset:5120
    v_mfma_f32_32x32x16_bf16 v[192:207], v[220:223], v[104:107], v[192:207]
    s_waitcnt lgkmcnt(4)
    v_mfma_f32_32x32x16_bf16 v[176:191], v[224:227], v[108:111], v[176:191]
    s_waitcnt lgkmcnt(2)
    v_mfma_f32_32x32x16_bf16 v[192:207], v[228:231], v[108:111], v[192:207]
    s_waitcnt lgkmcnt(1)
    v_mfma_f32_32x32x16_bf16 v[176:191], v[208:211], v[236:239], v[176:191]
    s_waitcnt lgkmcnt(0)
    v_mfma_f32_32x32x16_bf16 v[192:207], v[212:215], v[236:239], v[192:207]
    s_add_u32 m0, s46, 576
    s_mov_b64 exec, 1
    buffer_load_dword v255, s[36:39], 0 offen lds
    s_mov_b64 exec, -1
    s_and_b32 s63, s2, 8
    s_cmp_eq_u32 s44, s63
    s_cbranch_scc1 G_pass3
    s_add_u32 s56, s44, 32
    s_lshl_b32 s54, s56, 12
    s_add_u32 s54, s54, s100
    s_lshl_b32 s41, s56, 7
    s_add_u32 s41, s41, s101
    s_cmp_ge_u32 s56, 21
    s_cselect_b32 s57, 0, 0xff7fffff
    s_cselect_b32 s58, 1.0, 0
    s_cselect_b32 s59, 0, 1.0
    s_cmp_lt_u32 s56, 7
    s_cselect_b32 s59, 0x3e8b97f6, s59
    s_mov_b32 s47, s54
    s_setprio 2
    s_and_b32 s50, s2, 7
    s_lshl_b32 s50, s50, 1
    s_and_b32 s51, s42, 1
    s_add_u32 s50, s50, s51
    s_lshr_b32 s51, s42, 1
    s_mul_i32 s53, s50, 7
    s_lshr_b32 s53, s53, 1
    s_lshl_b32 s54, s51, 2
    s_add_u32 s52, s54, s40
    s_mul_i32 s55, s40, 3
    s_add_u32 s54, s54, s55
    s_sub_u32 s54, s54, 8
    v_and_b32 v216, 1, v240
    v_mul_u32_u24 v217, 3, v216
    v_add_u32 v217, s53, v217
    v_lshrrev_b32 v217, 3, v217
    v_bfe_u32 v218, v240, 1, 2
    v_add_u32 v219, s54, v218
    v_mov_b32 v220, s52
    v_cmp_eq_u32 vcc, 3, v218
    v_add_u32 v221, 7, v217
    v_mov_b32 v226, 0
    v_cndmask_b32 v219, v219, v220, vcc
    v_cndmask_b32 v221, v221, v217, vcc
    v_cmp_gt_i32 vcc, 0, v219
    v_add_u32 v217, 14, v217
    v_mov_b32 v227, 0
    v_cndmask_b32 v219, v219, v220, vcc
    v_cmp_lt_u32 vcc, 7, v240
    v_lshlrev_b32 v224, 13, v219
    v_add_u32 v224, 14942208, v224
    v_cndmask_b32 v221, v221, v217, vcc
    v_lshl_add_u32 v224, v221, 7, v224
    s_mov_b32 s100, 0xffff
    s_mov_b32 s101, 0
    s_and_b32 exec_lo, s100, 65535
    s_and_b32 exec_hi, s101, 0
    s_or_b32 exec_lo, exec_lo, 1
    buffer_load_dwordx2 v[226:227], v224, s[16:19], 0 offen sc1
    s_mov_b64 exec, -1
    v_mul_f32 v241, v235, v235
    v_mul_f32 v241, s58, v241
    v_mul_f32 v242, s59, v235
    v_max_f32 v176, s57, v176
    v_max_f32 v177, s57, v177
    v_fma_f32 v243, v176, v241, v242
    v_fma_f32 v254, v177, v241, v242
    v_mul_f32 v243, v176, v243
    v_mul_f32 v254, v177, v254
    v_cvt_pk_bf16_f32 v96, v243, v254
    v_max_f32 v178, s57, v178
    v_max_f32 v179, s57, v179
    v_fma_f32 v243, v178, v241, v242
    v_fma_f32 v254, v179, v241, v242
    v_mul_f32 v243, v178, v243
    v_mul_f32 v254, v179, v254
    v_cvt_pk_bf16_f32 v97, v243, v254
    v_max_f32 v180, s57, v180
    v_max_f32 v181, s57, v181
    v_fma_f32 v243, v180, v241, v242
    v_fma_f32 v254, v181, v241, v242
    v_mul_f32 v243, v180, v243
    v_mul_f32 v254, v181, v254
    v_cvt_pk_bf16_f32 v98, v243, v254
    v_max_f32 v182, s57, v182
    v_max_f32 v183, s57, v183
    v_fma_f32 v243, v182, v241, v242
    v_fma_f32 v254, v183, v241, v242
    v_mul_f32 v243, v182, v243
    v_mul_f32 v254, v183, v254
    v_cvt_pk_bf16_f32 v99, v243, v254
    v_max_f32 v184, s57, v184
    v_max_f32 v185, s57, v185
    v_fma_f32 v243, v184, v241, v242
    v_fma_f32 v254, v185, v241, v242
    v_mul_f32 v243, v184, v243
    v_mul_f32 v254, v185, v254
    v_cvt_pk_bf16_f32 v100, v243, v254
    v_max_f32 v186, s57, v186
    v_max_f32 v187, s57, v187
    v_fma_f32 v243, v186, v241, v242
    v_fma_f32 v254, v187, v241, v242
    v_mul_f32 v243, v186, v243
    v_mul_f32 v254, v187, v254
    v_cvt_pk_bf16_f32 v101, v243, v254
    v_max_f32 v188, s57, v188
    v_max_f32 v189, s57, v189
    v_fma_f32 v243, v188, v241, v242
    v_fma_f32 v254, v189, v241, v242
    v_mul_f32 v243, v188, v243
    v_mul_f32 v254, v189, v254
    v_cvt_pk_bf16_f32 v102, v243, v254
    v_max_f32 v190, s57, v190
    v_max_f32 v191, s57, v191
    v_fma_f32 v243, v190, v241, v242
    v_fma_f32 v254, v191, v241, v242
    v_mul_f32 v243, v190, v243
    v_mul_f32 v254, v191, v254
    v_cvt_pk_bf16_f32 v103, v243, v254
    v_max_f32 v192, s57, v192
    v_max_f32 v193, s57, v193
    v_fma_f32 v243, v192, v241, v242
    v_fma_f32 v254, v193, v241, v242
    v_mul_f32 v243, v192, v243
    v_mul_f32 v254, v193, v254
    v_cvt_pk_bf16_f32 v104, v243, v254
    v_max_f32 v194, s57, v194
    v_max_f32 v195, s57, v195
    v_fma_f32 v243, v194, v241, v242
    v_fma_f32 v254, v195, v241, v242
    v_mul_f32 v243, v194, v243
    v_mul_f32 v254, v195, v254
    v_cvt_pk_bf16_f32 v105, v243, v254
    v_max_f32 v196, s57, v196
    v_max_f32 v197, s57, v197
    v_fma_f32 v243, v196, v241, v242
    v_fma_f32 v254, v197, v241, v242
    v_mul_f32 v243, v196, v243
    v_mul_f32 v254, v197, v254
    v_cvt_pk_bf16_f32 v106, v243, v254
    v_max_f32 v198, s57, v198
    v_max_f32 v199, s57, v199
    v_fma_f32 v243, v198, v241, v242
    v_fma_f32 v254, v199, v241, v242
    v_mul_f32 v243, v198, v243
    v_mul_f32 v254, v199, v254
    v_cvt_pk_bf16_f32 v107, v243, v254
    v_max_f32 v200, s57, v200
    v_max_f32 v201, s57, v201
    v_fma_f32 v243, v200, v241, v242
    v_fma_f32 v254, v201, v241, v242
    v_mul_f32 v243, v200, v243
    v_mul_f32 v254, v201, v254
    v_cvt_pk_bf16_f32 v108, v243, v254
    v_max_f32 v202, s57, v202
    v_max_f32 v203, s57, v203
    v_fma_f32 v243, v202, v241, v242
    v_fma_f32 v254, v203, v241, v242
    v_mul_f32 v243, v202, v243
    v_mul_f32 v254, v203, v254
    v_cvt_pk_bf16_f32 v109, v243, v254
    v_max_f32 v204, s57, v204
    v_max_f32 v205, s57, v205
    v_fma_f32 v243, v204, v241, v242
    v_fma_f32 v254, v205, v241, v242
    v_mul_f32 v243, v204, v243
    v_mul_f32 v254, v205, v254
    v_cvt_pk_bf16_f32 v110, v243, v254
    v_max_f32 v206, s57, v206
    v_max_f32 v207, s57, v207
    v_fma_f32 v243, v206, v241, v242
    v_fma_f32 v254, v207, v241, v242
    v_mul_f32 v243, v206, v243
    v_mul_f32 v254, v207, v254
    v_cvt_pk_bf16_f32 v111, v243, v254
    s_mov_b32 s48, s41
G_attn:
    s_lshl_b32 s53, s53, 9
    s_mul_i32 s62, s40, 6144
    s_lshl_b32 s63, s40, 11
    s_and_b32 s58, s2, 8
    s_cmp_eq_u32 s44, s58
    s_mov_b32 s55, 81920
    s_cselect_b32 s55, 81920, s55
    s_mov_b32 s57, 114688
    s_cselect_b32 s57, 114688, s57
    ds_read_b128 v[244:247], v255 offset:576
    s_add_u32 s58, s55, s63
    s_add_u32 s45, s57, s63
    s_add_u32 s55, s55, s62
    s_add_u32 s57, s57, s62
    v_add_u32 v216, s58, v252
    v_lshrrev_b32 v229, 5, v240
    v_lshlrev_b32 v229, 6, v229
    v_xor_b32 v228, v252, v229
    v_xor_b32 v229, 128, v228
    v_mov_b32 v236, 0x3f803f80
    v_mov_b32 v237, 0x3f803f80
    v_mov_b32 v238, 0x3f803f80
    v_mov_b32 v239, 0x3f803f80
    s_bitcmp1_b32 s50, 0
    s_cselect_b32 s42, -1, 0
    s_mov_b32 s43, 0
    s_mov_b32 s58, 0
    s_cselect_b32 s59, 0, -1
    s_waitcnt lgkmcnt(0)
    v_or3_b32 v244, v244, v245, v246
    v_or_b32 v244, v244, v247
    v_cmp_ne_u32 vcc, 0, v244
    s_nop 4
    s_cbranch_vccnz SLOW_87
RET_88:
    s_waitcnt vmcnt(0)
    v_cmp_ne_u64 vcc, s[60:61], v[226:227]
    s_nop 0
    s_and_b64 s[100:101], s[100:101], vcc
    s_and_b32 s62, s100, 255
    s_cbranch_scc1 SLOW_89
RET_90:
    s_and_b32 exec_lo, s100, 65280
    s_and_b32 exec_hi, s101, 0
    s_or_b32 exec_lo, exec_lo, 256
    buffer_load_dwordx2 v[226:227], v224, s[16:19], 0 offen sc1
    s_mov_b64 exec, -1
    s_mul_i32 s63, s52, 200704
    s_add_u32 s63, s63, s53
    buffer_load_dwordx4 v[144:147], v252, s[16:19], s63 offen sc1
    buffer_load_dwordx4 v[148:151], v252, s[16:19], s63 offen offset:1024 sc1
    s_add_u32 s62, s54, 0
    s_mul_i32 s63, s62, 200704
    s_add_u32 s63, s63, s53
    s_add_u32 s63, s63, 28672
    s_cmp_lt_i32 s62, 0
    s_cselect_b32 s63, 134217728, s63
    s_add_u32 m0, s55, 0
    s_nop 0
    buffer_load_dwordx4 v252, s[16:19], s63 offen sc1 lds
    buffer_load_dwordx4 v252, s[16:19], s63 offen offset:1024 sc1 lds
    s_add_u32 s62, s54, 1
    s_mul_i32 s63, s62, 200704
    s_add_u32 s63, s63, s53
    s_add_u32 s63, s63, 28672
    s_cmp_lt_i32 s62, 0
    s_cselect_b32 s63, 134217728, s63
    s_add_u32 m0, s55, 2048
    s_nop 0
    buffer_load_dwordx4 v252, s[16:19], s63 offen sc1 lds
    buffer_load_dwordx4 v252, s[16:19], s63 offen offset:1024 sc1 lds
    s_add_u32 s62, s54, 2
    s_mul_i32 s63, s62, 200704
    s_add_u32 s63, s63, s53
    s_add_u32 s63, s63, 28672
    s_cmp_lt_i32 s62, 0
    s_cselect_b32 s63, 134217728, s63
    s_add_u32 m0, s55, 4096
    s_nop 0
    buffer_load_dwordx4 v252, s[16:19], s63 offen sc1 lds
    buffer_load_dwordx4 v252, s[16:19], s63 offen offset:1024 sc1 lds
    s_add_u32 m0, s46, 688
    s_mov_b64 exec, 1
    buffer_load_dword v255, s[36:39], 0 offen lds
    s_mov_b64 exec, -1
    v_mov_b32 v219, 0xffff
    v_mov_b32 v220, 0xffff0000
    v_cndmask_b32 v200, 0, v219, s[4:5]
    v_cndmask_b32 v221, 0, v220, s[6:7]
    v_or_b32 v200, v200, v221
    v_cndmask_b32 v201, 0, v219, s[8:9]
    v_cndmask_b32 v221, 0, v220, s[10:11]
    v_or_b32 v201, v201, v221
    v_cndmask_b32 v202, 0, v219, s[12:13]
    v_cndmask_b32 v221, 0, v220, s[14:15]
    v_or_b32 v202, v202, v221
    v_cndmask_b32 v203, 0, v219, s[20:21]
    v_cndmask_b32 v221, 0, v220, s[22:23]
    v_or_b32 v203, v203, v221
    v_cndmask_b32 v204, 0, v219, s[24:25]
    v_cndmask_b32 v221, 0, v220, s[26:27]
    v_or_b32 v204, v204, v221
    v_cndmask_b32 v205, 0, v219, s[28:29]
    v_cndmask_b32 v221, 0, v220, s[30:31]
    v_or_b32 v205, v205, v221
    v_cndmask_b32 v206, 0, v219, s[32:33]
    v_cndmask_b32 v221, 0, v220, s[34:35]
    v_or_b32 v206, v206, v221
    v_cndmask_b32 v207, 0, v219, s[96:97]
    v_cndmask_b32 v221, 0, v220, s[98:99]
    v_or_b32 v207, v207, v221
    v_bfe_u32 v219, v240, 4, 1
    v_lshlrev_b32 v219, 2, v219
    v_and_b32 v220, 1, v240
    v_lshl_add_u32 v219, v220, 1, v219
    v_bfe_u32 v220, v240, 1, 1
    v_add_u32 v219, v219, v220
    s_and_b32 s62, s50, 1
    v_add_u32 v219, s62, v219
    v_and_b32 v219, 7, v219
    v_lshrrev_b32 v220, 1, v219
    v_and_b32 v219, 1, v219
    v_lshlrev_b32 v222, 3, v219
    v_lshl_add_u32 v222, v220, 9, v222
    v_lshrrev_b32 v219, 5, v240
    v_xor_b32 v219, v219, v220
    v_lshl_add_u32 v222, v219, 6, v222
    v_bfe_u32 v219, v240, 2, 2
    v_lshl_add_u32 v222, v219, 4, v222
    v_add_u32 v222, s45, v222
    v_xor_b32 v223, 128, v222
    s_waitcnt vmcnt(8)
    v_cndmask_b32 v144, v144, 0, s[42:43]
    v_cndmask_b32 v145, v145, 0, s[42:43]
    s_waitcnt vmcnt(7)
    v_cndmask_b32 v150, v150, 0, s[58:59]
    v_cndmask_b32 v151, v151, 0, s[58:59]
    v_cmp_ne_u64 vcc, s[60:61], v[226:227]
    s_nop 0
    s_and_b64 s[100:101], s[100:101], vcc
    s_and_b32 s62, s100, 65280
    s_cbranch_scc1 SLOW_91
RET_92:
    s_add_u32 s62, s54, 0
    s_mul_i32 s63, s62, 200704
    s_add_u32 s63, s63, s53
    s_add_u32 s63, s63, 57344
    s_cmp_lt_i32 s62, 0
    s_cselect_b32 s63, 134217728, s63
    s_add_u32 m0, s57, 0
    s_nop 0
    buffer_load_dwordx4 v228, s[16:19], s63 offen sc1 lds
    buffer_load_dwordx4 v229, s[16:19], s63 offen offset:1024 sc1 lds
    s_add_u32 s62, s54, 1
    s_mul_i32 s63, s62, 200704
    s_add_u32 s63, s63, s53
    s_add_u32 s63, s63, 57344
    s_cmp_lt_i32 s62, 0
    s_cselect_b32 s63, 134217728, s63
    s_add_u32 m0, s57, 2048
    s_nop 0
    buffer_load_dwordx4 v228, s[16:19], s63 offen sc1 lds
    buffer_load_dwordx4 v229, s[16:19], s63 offen offset:1024 sc1 lds
    s_add_u32 s62, s54, 2
    s_mul_i32 s63, s62, 200704
    s_add_u32 s63, s63, s53
    s_add_u32 s63, s63, 57344
    s_cmp_lt_i32 s62, 0
    s_cselect_b32 s63, 134217728, s63
    s_add_u32 m0, s57, 4096
    s_nop 0
    buffer_load_dwordx4 v228, s[16:19], s63 offen sc1 lds
    buffer_load_dwordx4 v229, s[16:19], s63 offen offset:1024 sc1 lds
    s_add_u32 m0, s46, 704
    s_mov_b64 exec, 1
    buffer_load_dword v255, s[36:39], 0 offen lds
    s_mov_b64 exec, -1
    buffer_store_dwordx4 v[96:99], v252, s[16:19], s47 offen offset:0 sc1
    buffer_store_dwordx4 v[100:103], v252, s[16:19], s47 offen offset:1024 sc1
    buffer_store_dwordx4 v[104:107], v252, s[16:19], s47 offen offset:2048 sc1
    buffer_store_dwordx4 v[108:111], v252, s[16:19], s47 offen offset:3072 sc1
    s_cmp_ge_u32 s52, 7
    s_cselect_b32 s41, 0, 0xf149f2ca
    s_cmp_ge_u32 s52, 6
    s_cselect_b32 s44, 0, 0xf149f2ca
    s_cmp_ge_u32 s52, 5
    s_cselect_b32 s51, 0, 0xf149f2ca
    s_cmp_ge_u32 s52, 4
    s_cselect_b32 s56, 0, 0xf149f2ca
    s_cmp_ge_u32 s52, 3
    s_cselect_b32 s49, 0, 0xf149f2ca
    s_cmp_ge_u32 s52, 2
    s_cselect_b32 s55, 0, 0xf149f2ca
    s_cmp_ge_u32 s52, 1
    s_cselect_b32 s47, 0, 0xf149f2ca
    s_mov_b32 s63, 0
ZS_93:
    ds_read_b128 v[244:247], v255 offset:688
    s_add_u32 s63, s63, 1
    s_cmp_lt_u32 s63, 131072
    s_waitcnt lgkmcnt(0)
    v_or3_b32 v244, v244, v245, v246
    v_or_b32 v244, v244, v247
    v_cmp_ne_u32 vcc, 0, v244
    s_cbranch_scc0 ZD_94
    s_nop 3
    s_cbranch_vccnz ZS_93
ZD_94:
    ds_read_b128 v[152:155], v216 offset:0
    ds_read_b128 v[156:159], v216 offset:1024
    ds_read_b128 v[160:163], v216 offset:16384
    ds_read_b128 v[164:167], v216 offset:17408
    ds_read_b128 v[168:171], v216 offset:2048
    ds_read_b128 v[172:175], v216 offset:3072
    s_waitcnt lgkmcnt(5)
    v_mfma_f32_32x32x16_bf16 v[0:15], v[152:155], v[144:147], 0
    s_waitcnt lgkmcnt(4)
    v_mfma_f32_32x32x16_bf16 v[0:15], v[156:159], v[148:151], v[0:15]
    ds_read_b128 v[176:179], v216 offset:4096
    ds_read_b128 v[180:183], v216 offset:5120
    s_waitcnt lgkmcnt(5)
    v_mfma_f32_32x32x16_bf16 v[128:143], v[160:163], v[144:147], 0
    s_waitcnt lgkmcnt(4)
    v_mfma_f32_32x32x16_bf16 v[128:143], v[164:167], v[148:151], v[128:143]
    ds_read_b128 v[152:155], v216 offset:6144
    ds_read_b128 v[156:159], v216 offset:7168
    s_waitcnt lgkmcnt(5)
    v_mfma_f32_32x32x16_bf16 v[16:31], v[168:171], v[144:147], 0
    s_waitcnt lgkmcnt(4)
    v_mfma_f32_32x32x16_bf16 v[16:31], v[172:175], v[148:151], v[16:31]
    ds_read_b128 v[160:163], v216 offset:8192
    ds_read_b128 v[164:167], v216 offset:9216
    s_waitcnt lgkmcnt(5)
    v_mfma_f32_32x32x16_bf16 v[32:47], v[176:179], v[144:147], 0
    s_cmp_lt_u32 s52, 8
    s_cbranch_scc1 SLOW_95
RET_96:
    v_cndmask_b32 v128, v0, v128, s[4:5]
    v_cndmask_b32 v129, v1, v129, s[6:7]
    v_cndmask_b32 v130, v2, v130, s[8:9]
    v_cndmask_b32 v131, v3, v131, s[10:11]
    v_cndmask_b32 v132, v4, v132, s[12:13]
    s_waitcnt lgkmcnt(4)
    v_mfma_f32_32x32x16_bf16 v[32:47], v[180:183], v[148:151], v[32:47]
    ds_read_b128 v[168:171], v216 offset:10240
    ds_read_b128 v[172:175], v216 offset:11264
    v_cndmask_b32 v133, v5, v133, s[14:15]
    v_cndmask_b32 v134, v6, v134, s[20:21]
    v_cndmask_b32 v135, v7, v135, s[22:23]
    v_cndmask_b32 v136, v8, v136, s[24:25]
    s_waitcnt lgkmcnt(5)
    v_mfma_f32_32x32x16_bf16 v[48:63], v[152:155], v[144:147], 0
    v_cndmask_b32 v137, v9, v137, s[26:27]
    v_cndmask_b32 v138, v10, v138, s[28:29]
    v_cndmask_b32 v139, v11, v139, s[30:31]
    v_cndmask_b32 v140, v12, v140, s[32:33]
    v_cndmask_b32 v141, v13, v141, s[34:35]
    v_cndmask_b32 v142, v14, v142, s[96:97]
    s_waitcnt lgkmcnt(4)
    v_mfma_f32_32x32x16_bf16 v[48:63], v[156:159], v[148:151], v[48:63]
    ds_read_b128 v[176:179], v216 offset:12288
    ds_read_b128 v[180:183], v216 offset:13312
    v_cndmask_b32 v143, v15, v143, s[98:99]
    v_max3_f32 v219, v128, v129, v130
    v_max3_f32 v219, v219, v131, v132
    v_max3_f32 v219, v219, v133, v134
    s_waitcnt lgkmcnt(5)
    v_mfma_f32_32x32x16_bf16 v[64:79], v[160:163], v[144:147], 0
    v_max3_f32 v219, v219, v135, v136
    v_max3_f32 v219, v219, v137, v138
    v_max3_f32 v219, v219, v139, v140
    v_max3_f32 v219, v219, v141, v142
    v_max_f32 v218, v219, v143
    v_max3_f32 v220, v16, v17, v18
    s_waitcnt lgkmcnt(4)
    v_mfma_f32_32x32x16_bf16 v[64:79], v[164:167], v[148:151], v[64:79]
    ds_read_b128 v[152:155], v216 offset:14336
    ds_read_b128 v[156:159], v216 offset:15360
    v_max3_f32 v220, v220, v19, v20
    v_max3_f32 v220, v220, v21, v22
    v_max3_f32 v220, v220, v23, v24
    v_max3_f32 v220, v220, v25, v26
    s_waitcnt lgkmcnt(5)
    v_mfma_f32_32x32x16_bf16 v[80:95], v[168:171], v[144:147], 0
    v_max3_f32 v220, v220, v27, v28
    v_max3_f32 v220, v220, v29, v30
    v_max_f32 v220, v220, v31
    v_add_f32 v220, s41, v220
    v_max_f32 v218, v218, v220
    v_max3_f32 v219, v32, v33, v34
    s_waitcnt lgkmcnt(4)
    v_mfma_f32_32x32x16_bf16 v[80:95], v[172:175], v[148:151], v[80:95]
    v_max3_f32 v219, v219, v35, v36
    v_max3_f32 v219, v219, v37, v38
    v_max3_f32 v219, v219, v39, v40
    v_max3_f32 v219, v219, v41, v42
    v_max3_f32 v219, v219, v43, v44
    v_max3_f32 v219, v219, v45, v46
    s_waitcnt lgkmcnt(3)
    v_mfma_f32_32x32x16_bf16 v[96:111], v[176:179], v[144:147], 0
    v_max_f32 v219, v219, v47
    v_add_f32 v219, s44, v219
    v_max_f32 v218, v218, v219
    v_max3_f32 v220, v48, v49, v50
    v_max3_f32 v220, v220, v51, v52
    v_max3_f32 v220, v220, v53, v54
    s_waitcnt lgkmcnt(2)
    v_mfma_f32_32x32x16_bf16 v[96:111], v[180:183], v[148:151], v[96:111]
    v_max3_f32 v220, v220, v55, v56
    v_max3_f32 v220, v220, v57, v58
    v_max3_f32 v220, v220, v59, v60
    v_max3_f32 v220, v220, v61, v62
    v_max_f32 v220, v220, v63
    v_add_f32 v220, s51, v220
    s_waitcnt lgkmcnt(1)
    v_mfma_f32_32x32x16_bf16 v[112:127], v[152:155], v[144:147], 0
    v_max_f32 v218, v218, v220
    v_max3_f32 v219, v64, v65, v66
    v_max3_f32 v219, v219, v67, v68
    v_max3_f32 v219, v219, v69, v70
    v_max3_f32 v219, v219, v71, v72
    v_max3_f32 v219, v219, v73, v74
    s_waitcnt lgkmcnt(0)
    v_mfma_f32_32x32x16_bf16 v[112:127], v[156:159], v[148:151], v[112:127]
    v_max3_f32 v219, v219, v75, v76
    v_max3_f32 v219, v219, v77, v78
    v_max_f32 v219, v219, v79
    v_add_f32 v219, s56, v219
    v_max_f32 v218, v218, v219
    v_max3_f32 v220, v80, v81, v82
    v_max3_f32 v220, v220, v83, v84
    v_max3_f32 v220, v220, v85, v86
    v_max3_f32 v220, v220, v87, v88
    v_max3_f32 v220, v220, v89, v90
    v_max3_f32 v220, v220, v91, v92
    v_max3_f32 v220, v220, v93, v94
    v_max_f32 v220, v220, v95
    v_add_f32 v220, s49, v220
    v_max_f32 v218, v218, v220
    v_max3_f32 v219, v96, v97, v98
    v_max3_f32 v219, v219, v99, v100
    v_max3_f32 v219, v219, v101, v102
    v_max3_f32 v219, v219, v103, v104
    v_max3_f32 v219, v219, v105, v106
    v_max3_f32 v219, v219, v107, v108
    v_max3_f32 v219, v219, v109, v110
    v_max_f32 v219, v219, v111
    v_add_f32 v219, s55, v219
    v_max_f32 v218, v218, v219
    s_waitcnt vmcnt(0)
    v_mov_b32 v232, s60
    v_mov_b32 v233, s61
    v_lshlrev_b32 v234, 3, v240
    s_mov_b64 exec, 0xffff
    buffer_store_dwordx2 v[232:233], v234, s[16:19], s48 offen sc1
    s_mov_b64 exec, -1
    v_max3_f32 v220, v112, v113, v114
    v_max3_f32 v220, v220, v115, v116
    v_max3_f32 v220, v220, v117, v118
    v_max3_f32 v220, v220, v119, v120
    v_max3_f32 v220, v220, v121, v122
    v_max3_f32 v220, v220, v123, v124
    v_max3_f32 v220, v220, v125, v126
    v_max_f32 v220, v220, v127
    v_add_f32 v220, s47, v220
    v_max_f32 v218, v218, v220
    v_mov_b32 v219, v218
    ds_read_b128 v[244:247], v255 offset:704
    s_nop 0
    v_permlane32_swap_b32 v218, v219
    v_max_f32 v218, v218, v219
    v_sub_f32 v128, v128, v218
    v_sub_f32 v129, v129, v218
    v_sub_f32 v130, v130, v218
    v_sub_f32 v131, v131, v218
    v_sub_f32 v132, v132, v218
    v_sub_f32 v133, v133, v218
    v_sub_f32 v134, v134, v218
    v_sub_f32 v135, v135, v218
    v_exp_f32 v128, v128
    v_exp_f32 v129, v129
    v_exp_f32 v130, v130
    v_exp_f32 v131, v131
    v_exp_f32 v132, v132
    v_exp_f32 v133, v133
    v_exp_f32 v134, v134
    v_exp_f32 v135, v135
    v_sub_f32 v136, v136, v218
    v_sub_f32 v137, v137, v218
    v_sub_f32 v138, v138, v218
    v_sub_f32 v139, v139, v218
    v_sub_f32 v140, v140, v218
    v_sub_f32 v141, v141, v218
    v_sub_f32 v142, v142, v218
    v_sub_f32 v143, v143, v218
    v_exp_f32 v136, v136
    v_exp_f32 v137, v137
    v_exp_f32 v138, v138
    v_exp_f32 v139, v139
    v_exp_f32 v140, v140
    v_exp_f32 v141, v141
    v_exp_f32 v142, v142
    v_exp_f32 v143, v143
    v_cvt_pk_bf16_f32 v128, v128, v129
    v_cvt_pk_bf16_f32 v129, v130, v131
    v_cvt_pk_bf16_f32 v130, v132, v133
    v_cvt_pk_bf16_f32 v131, v134, v135
    v_cvt_pk_bf16_f32 v132, v136, v137
    v_cvt_pk_bf16_f32 v133, v138, v139
    v_cvt_pk_bf16_f32 v134, v140, v141
    v_cvt_pk_bf16_f32 v135, v142, v143
    v_bfi_b32 v208, v200, 0, v128
    v_and_b32 v136, v200, v128
    v_bfi_b32 v209, v201, 0, v129
    v_and_b32 v137, v201, v129
    v_bfi_b32 v210, v202, 0, v130
    v_and_b32 v138, v202, v130
    v_bfi_b32 v211, v203, 0, v131
    v_and_b32 v139, v203, v131
    v_bfi_b32 v212, v204, 0, v132
    v_and_b32 v140, v204, v132
    v_bfi_b32 v213, v205, 0, v133
    v_and_b32 v141, v205, v133
    v_bfi_b32 v214, v206, 0, v134
    v_and_b32 v142, v206, v134
    v_bfi_b32 v215, v207, 0, v135
    v_and_b32 v143, v207, v135
    s_waitcnt lgkmcnt(0)
    v_or3_b32 v244, v244, v245, v246
    v_or_b32 v244, v244, v247
    v_cmp_ne_u32 vcc, 0, v244
    s_nop 4
    s_cbranch_vccnz SLOW_97
RET_98:
    ds_read_b64_tr_b16 v[152:153], v222 offset:0
    ds_read_b64_tr_b16 v[154:155], v223 offset:0
    ds_read_b64_tr_b16 v[156:157], v222 offset:256
    ds_read_b64_tr_b16 v[158:159], v223 offset:256
    ds_read_b64_tr_b16 v[160:161], v222 offset:16384
    ds_read_b64_tr_b16 v[162:163], v223 offset:16384
    ds_read_b64_tr_b16 v[164:165], v222 offset:16640
    ds_read_b64_tr_b16 v[166:167], v223 offset:16640
    ds_read_b64_tr_b16 v[168:169], v222 offset:2048
    ds_read_b64_tr_b16 v[170:171], v223 offset:2048
    ds_read_b64_tr_b16 v[172:173], v222 offset:2304
    ds_read_b64_tr_b16 v[174:175], v223 offset:2304
    ds_read_b64_tr_b16 v[176:177], v222 offset:4096
    ds_read_b64_tr_b16 v[178:179], v223 offset:4096
    ds_read_b64_tr_b16 v[180:181], v222 offset:4352
    ds_read_b64_tr_b16 v[182:183], v223 offset:4352
    v_subrev_f32 v219, s41, v218
    v_mfma_f32_32x32x16_bf16 v[0:15], v[236:239], v[128:131], 0
    v_sub_f32 v16, v16, v219
    v_sub_f32 v17, v17, v219
    v_sub_f32 v18, v18, v219
    v_sub_f32 v19, v19, v219
    v_sub_f32 v20, v20, v219
    v_sub_f32 v21, v21, v219
    v_sub_f32 v22, v22, v219
    v_sub_f32 v23, v23, v219
    v_mfma_f32_32x32x16_bf16 v[0:15], v[236:239], v[132:135], v[0:15]
    v_exp_f32 v16, v16
    v_exp_f32 v17, v17
    v_exp_f32 v18, v18
    v_exp_f32 v19, v19
    v_exp_f32 v20, v20
    v_exp_f32 v21, v21
    v_exp_f32 v22, v22
    v_exp_f32 v23, v23
    v_sub_f32 v24, v24, v219
    v_sub_f32 v25, v25, v219
    v_sub_f32 v26, v26, v219
    v_sub_f32 v27, v27, v219
    v_sub_f32 v28, v28, v219
    v_sub_f32 v29, v29, v219
    v_sub_f32 v30, v30, v219
    v_sub_f32 v31, v31, v219
    v_exp_f32 v24, v24
    v_exp_f32 v25, v25
    v_exp_f32 v26, v26
    v_exp_f32 v27, v27
    v_exp_f32 v28, v28
    v_exp_f32 v29, v29
    v_exp_f32 v30, v30
    v_exp_f32 v31, v31
    v_cvt_pk_bf16_f32 v16, v16, v17
    v_cvt_pk_bf16_f32 v17, v18, v19
    v_cvt_pk_bf16_f32 v18, v20, v21
    v_cvt_pk_bf16_f32 v19, v22, v23
    v_cvt_pk_bf16_f32 v20, v24, v25
    v_cvt_pk_bf16_f32 v21, v26, v27
    v_cvt_pk_bf16_f32 v22, v28, v29
    v_cvt_pk_bf16_f32 v23, v30, v31
    v_subrev_f32 v219, s44, v218
    s_waitcnt lgkmcnt(14)
    v_mfma_f32_32x32x16_bf16 v[184:199], v[152:155], v[208:211], 0
    v_sub_f32 v32, v32, v219
    v_sub_f32 v33, v33, v219
    v_sub_f32 v34, v34, v219
    v_sub_f32 v35, v35, v219
    v_sub_f32 v36, v36, v219
    v_sub_f32 v37, v37, v219
    v_sub_f32 v38, v38, v219
    v_sub_f32 v39, v39, v219
    s_waitcnt lgkmcnt(12)
    v_mfma_f32_32x32x16_bf16 v[184:199], v[156:159], v[212:215], v[184:199]
    ds_read_b64_tr_b16 v[152:153], v222 offset:6144
    ds_read_b64_tr_b16 v[154:155], v223 offset:6144
    ds_read_b64_tr_b16 v[156:157], v222 offset:6400
    ds_read_b64_tr_b16 v[158:159], v223 offset:6400
    v_exp_f32 v32, v32
    v_exp_f32 v33, v33
    v_exp_f32 v34, v34
    v_exp_f32 v35, v35
    s_waitcnt lgkmcnt(14)
    v_mfma_f32_32x32x16_bf16 v[184:199], v[160:163], v[136:139], v[184:199]
    v_exp_f32 v36, v36
    v_exp_f32 v37, v37
    v_exp_f32 v38, v38
    v_exp_f32 v39, v39
    s_waitcnt lgkmcnt(12)
    v_mfma_f32_32x32x16_bf16 v[184:199], v[164:167], v[140:143], v[184:199]
    ds_read_b64_tr_b16 v[160:161], v222 offset:8192
    ds_read_b64_tr_b16 v[162:163], v223 offset:8192
    ds_read_b64_tr_b16 v[164:165], v222 offset:8448
    ds_read_b64_tr_b16 v[166:167], v223 offset:8448
    v_sub_f32 v40, v40, v219
    v_sub_f32 v41, v41, v219
    v_sub_f32 v42, v42, v219
    v_sub_f32 v43, v43, v219
    v_sub_f32 v44, v44, v219
    v_sub_f32 v45, v45, v219
    v_sub_f32 v46, v46, v219
    v_sub_f32 v47, v47, v219
    s_waitcnt lgkmcnt(14)
    v_mfma_f32_32x32x16_bf16 v[184:199], v[168:171], v[16:19], v[184:199]
    v_exp_f32 v40, v40
    v_exp_f32 v41, v41
    v_exp_f32 v42, v42
    v_exp_f32 v43, v43
    s_waitcnt lgkmcnt(12)
    v_mfma_f32_32x32x16_bf16 v[184:199], v[172:175], v[20:23], v[184:199]
    ds_read_b64_tr_b16 v[168:169], v222 offset:10240
    ds_read_b64_tr_b16 v[170:171], v223 offset:10240
    ds_read_b64_tr_b16 v[172:173], v222 offset:10496
    ds_read_b64_tr_b16 v[174:175], v223 offset:10496
    v_exp_f32 v44, v44
    v_exp_f32 v45, v45
    v_exp_f32 v46, v46
    v_exp_f32 v47, v47
    v_mfma_f32_32x32x16_bf16 v[0:15], v[236:239], v[16:19], v[0:15]
    v_cvt_pk_bf16_f32 v32, v32, v33
    v_cvt_pk_bf16_f32 v33, v34, v35
    v_cvt_pk_bf16_f32 v34, v36, v37
    v_cvt_pk_bf16_f32 v35, v38, v39
    v_cvt_pk_bf16_f32 v36, v40, v41
    v_cvt_pk_bf16_f32 v37, v42, v43
    v_cvt_pk_bf16_f32 v38, v44, v45
    v_cvt_pk_bf16_f32 v39, v46, v47
    v_mfma_f32_32x32x16_bf16 v[0:15], v[236:239], v[20:23], v[0:15]
    v_subrev_f32 v219, s51, v218
    v_sub_f32 v48, v48, v219
    v_sub_f32 v49, v49, v219
    v_sub_f32 v50, v50, v219
    v_sub_f32 v51, v51, v219
    v_sub_f32 v52, v52, v219
    v_sub_f32 v53, v53, v219
    v_sub_f32 v54, v54, v219
    s_waitcnt lgkmcnt(14)
    v_mfma_f32_32x32x16_bf16 v[184:199], v[176:179], v[32:35], v[184:199]
    v_sub_f32 v55, v55, v219
    v_exp_f32 v48, v48
    v_exp_f32 v49, v49
    v_exp_f32 v50, v50
    v_exp_f32 v51, v51
    s_waitcnt lgkmcnt(12)
    v_mfma_f32_32x32x16_bf16 v[184:199], v[180:183], v[36:39], v[184:199]
    ds_read_b64_tr_b16 v[176:177], v222 offset:12288
    ds_read_b64_tr_b16 v[178:179], v223 offset:12288
    ds_read_b64_tr_b16 v[180:181], v222 offset:12544
    ds_read_b64_tr_b16 v[182:183], v223 offset:12544
    v_exp_f32 v52, v52
    v_exp_f32 v53, v53
    v_exp_f32 v54, v54
    v_exp_f32 v55, v55
    v_mfma_f32_32x32x16_bf16 v[0:15], v[236:239], v[32:35], v[0:15]
    v_sub_f32 v56, v56, v219
    v_sub_f32 v57, v57, v219
    v_sub_f32 v58, v58, v219
    v_sub_f32 v59, v59, v219
    v_sub_f32 v60, v60, v219
    v_sub_f32 v61, v61, v219
    v_sub_f32 v62, v62, v219
    v_sub_f32 v63, v63, v219
    v_mfma_f32_32x32x16_bf16 v[0:15], v[236:239], v[36:39], v[0:15]
    v_exp_f32 v56, v56
    v_exp_f32 v57, v57
    v_exp_f32 v58, v58
    v_exp_f32 v59, v59
    v_exp_f32 v60, v60
    v_exp_f32 v61, v61
    v_exp_f32 v62, v62
    v_exp_f32 v63, v63
    v_cvt_pk_bf16_f32 v48, v48, v49
    v_cvt_pk_bf16_f32 v49, v50, v51
    v_cvt_pk_bf16_f32 v50, v52, v53
    v_cvt_pk_bf16_f32 v51, v54, v55
    v_cvt_pk_bf16_f32 v52, v56, v57
    v_cvt_pk_bf16_f32 v53, v58, v59
    v_cvt_pk_bf16_f32 v54, v60, v61
    v_cvt_pk_bf16_f32 v55, v62, v63
    v_subrev_f32 v219, s56, v218
    s_waitcnt lgkmcnt(14)
    v_mfma_f32_32x32x16_bf16 v[184:199], v[152:155], v[48:51], v[184:199]
    v_sub_f32 v64, v64, v219
    v_sub_f32 v65, v65, v219
    v_sub_f32 v66, v66, v219
    v_sub_f32 v67, v67, v219
    v_sub_f32 v68, v68, v219
    v_sub_f32 v69, v69, v219
    v_sub_f32 v70, v70, v219
    v_sub_f32 v71, v71, v219
    s_waitcnt lgkmcnt(12)
    v_mfma_f32_32x32x16_bf16 v[184:199], v[156:159], v[52:55], v[184:199]
    ds_read_b64_tr_b16 v[152:153], v222 offset:14336
    ds_read_b64_tr_b16 v[154:155], v223 offset:14336
    ds_read_b64_tr_b16 v[156:157], v222 offset:14592
    ds_read_b64_tr_b16 v[158:159], v223 offset:14592
    v_exp_f32 v64, v64
    v_exp_f32 v65, v65
    v_exp_f32 v66, v66
    v_exp_f32 v67, v67
    v_mfma_f32_32x32x16_bf16 v[0:15], v[236:239], v[48:51], v[0:15]
    v_exp_f32 v68, v68
    v_exp_f32 v69, v69
    v_exp_f32 v70, v70
    v_exp_f32 v71, v71
    v_mfma_f32_32x32x16_bf16 v[0:15], v[236:239], v[52:55], v[0:15]
    v_sub_f32 v72, v72, v219
    v_sub_f32 v73, v73, v219
    v_sub_f32 v74, v74, v219
    v_sub_f32 v75, v75, v219
    v_sub_f32 v76, v76, v219
    v_sub_f32 v77, v77, v219
    v_sub_f32 v78, v78, v219
    v_sub_f32 v79, v79, v219
    v_exp_f32 v72, v72
    v_exp_f32 v73, v73
    v_exp_f32 v74, v74
    v_exp_f32 v75, v75
    v_exp_f32 v76, v76
    v_exp_f32 v77, v77
    v_exp_f32 v78, v78
    v_exp_f32 v79, v79
    v_cvt_pk_bf16_f32 v64, v64, v65
    v_cvt_pk_bf16_f32 v65, v66, v67
    v_cvt_pk_bf16_f32 v66, v68, v69
    v_cvt_pk_bf16_f32 v67, v70, v71
    v_cvt_pk_bf16_f32 v68, v72, v73
    v_cvt_pk_bf16_f32 v69, v74, v75
    v_cvt_pk_bf16_f32 v70, v76, v77
    v_cvt_pk_bf16_f32 v71, v78, v79
    v_subrev_f32 v219, s49, v218
    s_waitcnt lgkmcnt(14)
    v_mfma_f32_32x32x16_bf16 v[184:199], v[160:163], v[64:67], v[184:199]
    v_sub_f32 v80, v80, v219
    v_sub_f32 v81, v81, v219
    v_sub_f32 v82, v82, v219
    v_sub_f32 v83, v83, v219
    v_sub_f32 v84, v84, v219
    v_sub_f32 v85, v85, v219
    v_sub_f32 v86, v86, v219
    v_sub_f32 v87, v87, v219
    s_waitcnt lgkmcnt(12)
    v_mfma_f32_32x32x16_bf16 v[184:199], v[164:167], v[68:71], v[184:199]
    v_exp_f32 v80, v80
    v_exp_f32 v81, v81
    v_exp_f32 v82, v82
    v_exp_f32 v83, v83
    v_mfma_f32_32x32x16_bf16 v[0:15], v[236:239], v[64:67], v[0:15]
    v_exp_f32 v84, v84
    v_exp_f32 v85, v85
    v_exp_f32 v86, v86
    v_exp_f32 v87, v87
    v_mfma_f32_32x32x16_bf16 v[0:15], v[236:239], v[68:71], v[0:15]
    v_sub_f32 v88, v88, v219
    v_sub_f32 v89, v89, v219
    v_sub_f32 v90, v90, v219
    v_sub_f32 v91, v91, v219
    v_sub_f32 v92, v92, v219
    v_sub_f32 v93, v93, v219
    v_sub_f32 v94, v94, v219
    v_sub_f32 v95, v95, v219
    v_exp_f32 v88, v88
    v_exp_f32 v89, v89
    v_exp_f32 v90, v90
    v_exp_f32 v91, v91
    v_exp_f32 v92, v92
    v_exp_f32 v93, v93
    v_exp_f32 v94, v94
    v_exp_f32 v95, v95
    v_cvt_pk_bf16_f32 v80, v80, v81
    v_cvt_pk_bf16_f32 v81, v82, v83
    v_cvt_pk_bf16_f32 v82, v84, v85
    v_cvt_pk_bf16_f32 v83, v86, v87
    v_cvt_pk_bf16_f32 v84, v88, v89
    v_cvt_pk_bf16_f32 v85, v90, v91
    v_cvt_pk_bf16_f32 v86, v92, v93
    v_cvt_pk_bf16_f32 v87, v94, v95
    v_subrev_f32 v219, s55, v218
    s_waitcnt lgkmcnt(10)
    v_mfma_f32_32x32x16_bf16 v[184:199], v[168:171], v[80:83], v[184:199]
    v_sub_f32 v96, v96, v219
    v_sub_f32 v97, v97, v219
    v_sub_f32 v98, v98, v219
    v_sub_f32 v99, v99, v219
    v_sub_f32 v100, v100, v219
    v_sub_f32 v101, v101, v219
    v_sub_f32 v102, v102, v219
    v_sub_f32 v103, v103, v219
    s_waitcnt lgkmcnt(8)
    v_mfma_f32_32x32x16_bf16 v[184:199], v[172:175], v[84:87], v[184:199]
    v_exp_f32 v96, v96
    v_exp_f32 v97, v97
    v_exp_f32 v98, v98
    v_exp_f32 v99, v99
    v_mfma_f32_32x32x16_bf16 v[0:15], v[236:239], v[80:83], v[0:15]
    v_exp_f32 v100, v100
    v_exp_f32 v101, v101
    v_exp_f32 v102, v102
    v_exp_f32 v103, v103
    v_mfma_f32_32x32x16_bf16 v[0:15], v[236:239], v[84:87], v[0:15]
    v_sub_f32 v104, v104, v219
    v_sub_f32 v105, v105, v219
    v_sub_f32 v106, v106, v219
    v_sub_f32 v107, v107, v219
    v_sub_f32 v108, v108, v219
    v_sub_f32 v109, v109, v219
    v_sub_f32 v110, v110, v219
    v_sub_f32 v111, v111, v219
    v_exp_f32 v104, v104
    v_exp_f32 v105, v105
    v_exp_f32 v106, v106
    v_exp_f32 v107, v107
    v_exp_f32 v108, v108
    v_exp_f32 v109, v109
    v_exp_f32 v110, v110
    v_exp_f32 v111, v111
    v_cvt_pk_bf16_f32 v96, v96, v97
    v_cvt_pk_bf16_f32 v97, v98, v99
    v_cvt_pk_bf16_f32 v98, v100, v101
    v_cvt_pk_bf16_f32 v99, v102, v103
    v_cvt_pk_bf16_f32 v100, v104, v105
    v_cvt_pk_bf16_f32 v101, v106, v107
    v_cvt_pk_bf16_f32 v102, v108, v109
    v_cvt_pk_bf16_f32 v103, v110, v111
    v_subrev_f32 v219, s47, v218
    s_waitcnt lgkmcnt(6)
    v_mfma_f32_32x32x16_bf16 v[184:199], v[176:179], v[96:99], v[184:199]
    v_sub_f32 v112, v112, v219
    v_sub_f32 v113, v113, v219
    v_sub_f32 v114, v114, v219
    v_sub_f32 v115, v115, v219
    v_sub_f32 v116, v116, v219
    v_sub_f32 v117, v117, v219
    v_sub_f32 v118, v118, v219
    v_sub_f32 v119, v119, v219
    s_waitcnt lgkmcnt(4)
    v_mfma_f32_32x32x16_bf16 v[184:199], v[180:183], v[100:103], v[184:199]
    v_exp_f32 v112, v112
    v_exp_f32 v113, v113
    v_exp_f32 v114, v114
    v_exp_f32 v115, v115
    v_mfma_f32_32x32x16_bf16 v[0:15], v[236:239], v[96:99], v[0:15]
    v_exp_f32 v116, v116
    v_exp_f32 v117, v117
    v_exp_f32 v118, v118
    v_exp_f32 v119, v119
    v_mfma_f32_32x32x16_bf16 v[0:15], v[236:239], v[100:103], v[0:15]
    v_sub_f32 v120, v120, v219
    v_sub_f32 v121, v121, v219
    v_sub_f32 v122, v122, v219
    v_sub_f32 v123, v123, v219
    v_sub_f32 v124, v124, v219
    v_sub_f32 v125, v125, v219
    v_sub_f32 v126, v126, v219
    v_sub_f32 v127, v127, v219
    v_exp_f32 v120, v120
    v_exp_f32 v121, v121
    v_exp_f32 v122, v122
    v_exp_f32 v123, v123
    v_exp_f32 v124, v124
    v_exp_f32 v125, v125
    v_exp_f32 v126, v126
    v_exp_f32 v127, v127
    v_cvt_pk_bf16_f32 v112, v112, v113
    v_cvt_pk_bf16_f32 v113, v114, v115
    v_cvt_pk_bf16_f32 v114, v116, v117
    v_cvt_pk_bf16_f32 v115, v118, v119
    v_cvt_pk_bf16_f32 v116, v120, v121
    v_cvt_pk_bf16_f32 v117, v122, v123
    v_cvt_pk_bf16_f32 v118, v124, v125
    v_cvt_pk_bf16_f32 v119, v126, v127
    v_mfma_f32_32x32x16_bf16 v[0:15], v[236:239], v[112:115], v[0:15]
    s_nop 0
    v_mfma_f32_32x32x16_bf16 v[0:15], v[236:239], v[116:119], v[0:15]
    s_waitcnt lgkmcnt(2)
    v_mfma_f32_32x32x16_bf16 v[184:199], v[152:155], v[112:115], v[184:199]
    s_waitcnt lgkmcnt(0)
    v_mfma_f32_32x32x16_bf16 v[184:199], v[156:159], v[116:119], v[184:199]
    s_nop 7
    v_rcp_f32 v219, v0
    s_lshl_b32 s53, s52, 15
    s_lshl_b32 s54, s50, 11
    s_add_u32 s53, s53, s54
    s_add_u32 s53, s53, 12845056
    s_mov_b32 s56, 0
    s_mov_b32 s57, -1
    v_mul_f32 v184, v184, v219
    v_mul_f32 v185, v185, v219
    v_mul_f32 v186, v186, v219
    v_mul_f32 v187, v187, v219
    v_mul_f32 v188, v188, v219
    v_mul_f32 v189, v189, v219
    v_mul_f32 v190, v190, v219
    v_mul_f32 v191, v191, v219
    v_mul_f32 v192, v192, v219
    v_mul_f32 v193, v193, v219
    v_mul_f32 v194, v194, v219
    v_mul_f32 v195, v195, v219
    v_mul_f32 v196, v196, v219
    v_mul_f32 v197, v197, v219
    v_mul_f32 v198, v198, v219
    v_mul_f32 v199, v199, v219
    v_cvt_pk_bf16_f32 v184, v184, v185
    v_cvt_pk_bf16_f32 v185, v186, v187
    v_cvt_pk_bf16_f32 v186, v188, v189
    v_cvt_pk_bf16_f32 v187, v190, v191
    v_cvt_pk_bf16_f32 v188, v192, v193
    v_cvt_pk_bf16_f32 v189, v194, v195
    v_cvt_pk_bf16_f32 v190, v196, v197
    v_cvt_pk_bf16_f32 v191, v198, v199
    v_cndmask_b32 v190, v190, 0, s[56:57]
    v_cndmask_b32 v191, v191, 0, s[56:57]
    buffer_store_dwordx4 v[184:187], v252, s[16:19], s53 offen sc1
    buffer_store_dwordx4 v[188:191], v252, s[16:19], s53 offen offset:1024 sc1
    s_lshl_b32 s53, s52, 11
    s_lshl_b32 s54, s50, 7
    s_add_u32 s53, s53, s54
    s_add_u32 s53, s53, 15466496
    s_waitcnt vmcnt(0)
    v_mov_b32 v232, s60
    v_mov_b32 v233, s61
    v_lshlrev_b32 v234, 3, v240
    s_mov_b64 exec, 0xffff
    buffer_store_dwordx2 v[232:233], v234, s[16:19], s53 offen sc1
    s_mov_b64 exec, -1
    s_endpgm
G_pass3:
    s_mov_b32 s63, 0
ZS_99:
    ds_read_b128 v[244:247], v255 offset:224
    s_add_u32 s63, s63, 1
    s_cmp_lt_u32 s63, 131072
    s_waitcnt lgkmcnt(0)
    v_or3_b32 v244, v244, v245, v246
    v_or_b32 v244, v244, v247
    v_cmp_ne_u32 vcc, 0, v244
    s_cbranch_scc0 ZD_100
    s_nop 3
    s_cbranch_vccnz ZS_99
ZD_100:
    ds_read_b64_tr_b16 v[224:225], v248 offset:0
    ds_read_b64_tr_b16 v[226:227], v248 offset:512
    ds_read_b64_tr_b16 v[228:229], v249 offset:0
    ds_read_b64_tr_b16 v[230:231], v249 offset:512
    ds_read_b64_tr_b16 v[208:209], v248 offset:2048
    ds_read_b64_tr_b16 v[210:211], v248 offset:2560
    ds_read_b64_tr_b16 v[212:213], v249 offset:2048
    ds_read_b64_tr_b16 v[214:215], v249 offset:2560
    ds_read_b128 v[244:247], v255 offset:256
    s_mov_b32 s43, 0
    s_mov_b32 s45, 0
    s_waitcnt lgkmcnt(7)
    v_mfma_f32_32x32x16_bf16 v[112:127], v[224:227], v[0:3], 0
    ds_read_b64_tr_b16 v[216:217], v248 offset:4096
    ds_read_b64_tr_b16 v[218:219], v248 offset:4608
    ds_read_b64_tr_b16 v[220:221], v249 offset:4096
    ds_read_b64_tr_b16 v[222:223], v249 offset:4608
    s_add_u32 s56, s44, 32
    s_lshl_b32 s54, s56, 12
    s_add_u32 s54, s54, s100
    s_lshl_b32 s41, s56, 7
    s_add_u32 s41, s41, s101
    s_cmp_ge_u32 s56, 21
    s_cselect_b32 s57, 0, 0xff7fffff
    s_cselect_b32 s58, 1.0, 0
    s_cselect_b32 s59, 0, 1.0
    s_waitcnt lgkmcnt(9)
    v_mfma_f32_32x32x16_bf16 v[128:143], v[228:231], v[0:3], 0
    s_cmp_lt_u32 s56, 7
    s_cselect_b32 s59, 0x3e8b97f6, s59
    v_mul_f32 v241, v235, v235
    v_mul_f32 v241, s58, v241
    v_mul_f32 v242, s59, v235
    v_max_f32 v176, s57, v176
    v_max_f32 v177, s57, v177
    v_fma_f32 v243, v176, v241, v242
    v_fma_f32 v254, v177, v241, v242
    s_waitcnt lgkmcnt(7)
    v_mfma_f32_32x32x16_bf16 v[112:127], v[208:211], v[4:7], v[112:127]
    ds_read_b64_tr_b16 v[224:225], v248 offset:6144
    ds_read_b64_tr_b16 v[226:227], v248 offset:6656
    ds_read_b64_tr_b16 v[228:229], v249 offset:6144
    ds_read_b64_tr_b16 v[230:231], v249 offset:6656
    v_mul_f32 v243, v176, v243
    v_mul_f32 v254, v177, v254
    v_cvt_pk_bf16_f32 v176, v243, v254
    v_max_f32 v178, s57, v178
    v_max_f32 v179, s57, v179
    v_fma_f32 v243, v178, v241, v242
    v_fma_f32 v254, v179, v241, v242
    v_mul_f32 v243, v178, v243
    v_mul_f32 v254, v179, v254
    v_cvt_pk_bf16_f32 v177, v243, v254
    v_max_f32 v180, s57, v180
    v_max_f32 v181, s57, v181
    s_waitcnt lgkmcnt(9)
    v_mfma_f32_32x32x16_bf16 v[128:143], v[212:215], v[4:7], v[128:143]
    v_fma_f32 v243, v180, v241, v242
    v_fma_f32 v254, v181, v241, v242
    v_mul_f32 v243, v180, v243
    v_mul_f32 v254, v181, v254
    v_cvt_pk_bf16_f32 v178, v243, v254
    v_max_f32 v182, s57, v182
    v_max_f32 v183, s57, v183
    v_fma_f32 v243, v182, v241, v242
    v_fma_f32 v254, v183, v241, v242
    v_mul_f32 v243, v182, v243
    v_mul_f32 v254, v183, v254
    v_cvt_pk_bf16_f32 v179, v243, v254
    s_waitcnt lgkmcnt(6)
    v_mfma_f32_32x32x16_bf16 v[112:127], v[216:219], v[8:11], v[112:127]
    v_or3_b32 v244, v244, v245, v246
    v_or_b32 v244, v244, v247
    v_cmp_ne_u32 vcc, 0, v244
    s_nop 4
    s_cbranch_vccnz SLOW_101
RET_102:
    ds_read_b64_tr_b16 v[208:209], v248 offset:8192
    ds_read_b64_tr_b16 v[210:211], v248 offset:8704
    ds_read_b64_tr_b16 v[212:213], v249 offset:8192
    ds_read_b64_tr_b16 v[214:215], v249 offset:8704
    buffer_store_dwordx4 v[176:179], v252, s[16:19], s54 offen offset:0 sc1
    v_max_f32 v184, s57, v184
    v_max_f32 v185, s57, v185
    v_fma_f32 v243, v184, v241, v242
    v_fma_f32 v254, v185, v241, v242
    v_mul_f32 v243, v184, v243
    v_mul_f32 v254, v185, v254
    v_cvt_pk_bf16_f32 v184, v243, v254
    v_max_f32 v186, s57, v186
    v_max_f32 v187, s57, v187
    v_fma_f32 v243, v186, v241, v242
    v_fma_f32 v254, v187, v241, v242
    s_waitcnt lgkmcnt(8)
    v_mfma_f32_32x32x16_bf16 v[128:143], v[220:223], v[8:11], v[128:143]
    v_mul_f32 v243, v186, v243
    v_mul_f32 v254, v187, v254
    v_cvt_pk_bf16_f32 v185, v243, v254
    v_max_f32 v188, s57, v188
    v_max_f32 v189, s57, v189
    v_fma_f32 v243, v188, v241, v242
    v_fma_f32 v254, v189, v241, v242
    v_mul_f32 v243, v188, v243
    v_mul_f32 v254, v189, v254
    v_cvt_pk_bf16_f32 v186, v243, v254
    v_max_f32 v190, s57, v190
    v_max_f32 v191, s57, v191
    s_waitcnt lgkmcnt(6)
    v_mfma_f32_32x32x16_bf16 v[112:127], v[224:227], v[12:15], v[112:127]
    ds_read_b64_tr_b16 v[216:217], v248 offset:10240
    ds_read_b64_tr_b16 v[218:219], v248 offset:10752
    ds_read_b64_tr_b16 v[220:221], v249 offset:10240
    ds_read_b64_tr_b16 v[222:223], v249 offset:10752
    v_fma_f32 v243, v190, v241, v242
    v_fma_f32 v254, v191, v241, v242
    v_mul_f32 v243, v190, v243
    v_mul_f32 v254, v191, v254
    v_cvt_pk_bf16_f32 v187, v243, v254
    buffer_store_dwordx4 v[184:187], v252, s[16:19], s54 offen offset:1024 sc1
    v_max_f32 v192, s57, v192
    v_max_f32 v193, s57, v193
    v_fma_f32 v243, v192, v241, v242
    v_fma_f32 v254, v193, v241, v242
    v_mul_f32 v243, v192, v243
    v_mul_f32 v254, v193, v254
    s_waitcnt lgkmcnt(8)
    v_mfma_f32_32x32x16_bf16 v[128:143], v[228:231], v[12:15], v[128:143]
    v_cvt_pk_bf16_f32 v192, v243, v254
    v_max_f32 v194, s57, v194
    v_max_f32 v195, s57, v195
    v_fma_f32 v243, v194, v241, v242
    v_fma_f32 v254, v195, v241, v242
    v_mul_f32 v243, v194, v243
    v_mul_f32 v254, v195, v254
    v_cvt_pk_bf16_f32 v193, v243, v254
    v_max_f32 v196, s57, v196
    v_max_f32 v197, s57, v197
    v_fma_f32 v243, v196, v241, v242
    v_fma_f32 v254, v197, v241, v242
    s_waitcnt lgkmcnt(6)
    v_mfma_f32_32x32x16_bf16 v[112:127], v[208:211], v[16:19], v[112:127]
    ds_read_b64_tr_b16 v[224:225], v248 offset:12288
    ds_read_b64_tr_b16 v[226:227], v248 offset:12800
    ds_read_b64_tr_b16 v[228:229], v249 offset:12288
    ds_read_b64_tr_b16 v[230:231], v249 offset:12800
    v_mul_f32 v243, v196, v243
    v_mul_f32 v254, v197, v254
    v_cvt_pk_bf16_f32 v194, v243, v254
    v_max_f32 v198, s57, v198
    v_max_f32 v199, s57, v199
    v_fma_f32 v243, v198, v241, v242
    v_fma_f32 v254, v199, v241, v242
    v_mul_f32 v243, v198, v243
    v_mul_f32 v254, v199, v254
    v_cvt_pk_bf16_f32 v195, v243, v254
    buffer_store_dwordx4 v[192:195], v252, s[16:19], s54 offen offset:2048 sc1
    v_max_f32 v200, s57, v200
    s_waitcnt lgkmcnt(8)
    v_mfma_f32_32x32x16_bf16 v[128:143], v[212:215], v[16:19], v[128:143]
    v_max_f32 v201, s57, v201
    v_fma_f32 v243, v200, v241, v242
    v_fma_f32 v254, v201, v241, v242
    v_mul_f32 v243, v200, v243
    v_mul_f32 v254, v201, v254
    v_cvt_pk_bf16_f32 v200, v243, v254
    v_max_f32 v202, s57, v202
    v_max_f32 v203, s57, v203
    v_fma_f32 v243, v202, v241, v242
    v_fma_f32 v254, v203, v241, v242
    v_mul_f32 v243, v202, v243
    v_mul_f32 v254, v203, v254
    s_waitcnt lgkmcnt(6)
    v_mfma_f32_32x32x16_bf16 v[112:127], v[216:219], v[20:23], v[112:127]
    ds_read_b64_tr_b16 v[208:209], v248 offset:14336
    ds_read_b64_tr_b16 v[210:211], v248 offset:14848
    ds_read_b64_tr_b16 v[212:213], v249 offset:14336
    ds_read_b64_tr_b16 v[214:215], v249 offset:14848
    v_cvt_pk_bf16_f32 v201, v243, v254
    v_max_f32 v204, s57, v204
    v_max_f32 v205, s57, v205
    v_fma_f32 v243, v204, v241, v242
    v_fma_f32 v254, v205, v241, v242
    v_mul_f32 v243, v204, v243
    v_mul_f32 v254, v205, v254
    v_cvt_pk_bf16_f32 v202, v243, v254
    v_max_f32 v206, s57, v206
    v_max_f32 v207, s57, v207
    v_fma_f32 v243, v206, v241, v242
    v_fma_f32 v254, v207, v241, v242
    s_waitcnt lgkmcnt(8)
    v_mfma_f32_32x32x16_bf16 v[128:143], v[220:223], v[20:23], v[128:143]
    v_mul_f32 v243, v206, v243
    v_mul_f32 v254, v207, v254
    v_cvt_pk_bf16_f32 v203, v243, v254
    buffer_store_dwordx4 v[200:203], v252, s[16:19], s54 offen offset:3072 sc1
    s_waitcnt lgkmcnt(6)
    v_mfma_f32_32x32x16_bf16 v[112:127], v[224:227], v[24:27], v[112:127]
    ds_read_b64_tr_b16 v[216:217], v248 offset:16384
    ds_read_b64_tr_b16 v[218:219], v248 offset:16896
    ds_read_b64_tr_b16 v[220:221], v249 offset:16384
    ds_read_b64_tr_b16 v[222:223], v249 offset:16896
    s_waitcnt lgkmcnt(8)
    v_mfma_f32_32x32x16_bf16 v[128:143], v[228:231], v[24:27], v[128:143]
    s_waitcnt lgkmcnt(6)
    v_mfma_f32_32x32x16_bf16 v[112:127], v[208:211], v[28:31], v[112:127]
    ds_read_b64_tr_b16 v[224:225], v248 offset:18432
    ds_read_b64_tr_b16 v[226:227], v248 offset:18944
    ds_read_b64_tr_b16 v[228:229], v249 offset:18432
    ds_read_b64_tr_b16 v[230:231], v249 offset:18944
    s_waitcnt lgkmcnt(8)
    v_mfma_f32_32x32x16_bf16 v[128:143], v[212:215], v[28:31], v[128:143]
    s_waitcnt lgkmcnt(6)
    v_mfma_f32_32x32x16_bf16 v[112:127], v[216:219], v[32:35], v[112:127]
    ds_read_b64_tr_b16 v[208:209], v248 offset:20480
    ds_read_b64_tr_b16 v[210:211], v248 offset:20992
    ds_read_b64_tr_b16 v[212:213], v249 offset:20480
    ds_read_b64_tr_b16 v[214:215], v249 offset:20992
    ds_read_b128 v[244:247], v255 offset:288
    s_waitcnt lgkmcnt(9)
    v_mfma_f32_32x32x16_bf16 v[128:143], v[220:223], v[32:35], v[128:143]
    s_waitcnt lgkmcnt(7)
    v_mfma_f32_32x32x16_bf16 v[112:127], v[224:227], v[36:39], v[112:127]
    ds_read_b64_tr_b16 v[216:217], v248 offset:22528
    ds_read_b64_tr_b16 v[218:219], v248 offset:23040
    ds_read_b64_tr_b16 v[220:221], v249 offset:22528
    ds_read_b64_tr_b16 v[222:223], v249 offset:23040
    s_waitcnt lgkmcnt(9)
    v_mfma_f32_32x32x16_bf16 v[128:143], v[228:231], v[36:39], v[128:143]
    s_waitcnt lgkmcnt(7)
    v_mfma_f32_32x32x16_bf16 v[112:127], v[208:211], v[40:43], v[112:127]
    s_waitcnt lgkmcnt(4)
    v_or3_b32 v244, v244, v245, v246
    v_or_b32 v244, v244, v247
    v_cmp_ne_u32 vcc, 0, v244
    s_nop 4
    s_cbranch_vccnz SLOW_103
RET_104:
    ds_read_b64_tr_b16 v[224:225], v248 offset:24576
    ds_read_b64_tr_b16 v[226:227], v248 offset:25088
    ds_read_b64_tr_b16 v[228:229], v249 offset:24576
    ds_read_b64_tr_b16 v[230:231], v249 offset:25088
    v_mfma_f32_32x32x16_bf16 v[128:143], v[212:215], v[40:43], v[128:143]
    s_waitcnt lgkmcnt(6)
    v_mfma_f32_32x32x16_bf16 v[112:127], v[216:219], v[44:47], v[112:127]
    ds_read_b64_tr_b16 v[208:209], v248 offset:26624
    ds_read_b64_tr_b16 v[210:211], v248 offset:27136
    ds_read_b64_tr_b16 v[212:213], v249 offset:26624
    ds_read_b64_tr_b16 v[214:215], v249 offset:27136
    s_waitcnt lgkmcnt(8)
    v_mfma_f32_32x32x16_bf16 v[128:143], v[220:223], v[44:47], v[128:143]
    s_waitcnt lgkmcnt(6)
    v_mfma_f32_32x32x16_bf16 v[112:127], v[224:227], v[48:51], v[112:127]
    ds_read_b64_tr_b16 v[216:217], v248 offset:28672
    ds_read_b64_tr_b16 v[218:219], v248 offset:29184
    ds_read_b64_tr_b16 v[220:221], v249 offset:28672
    ds_read_b64_tr_b16 v[222:223], v249 offset:29184
    s_waitcnt lgkmcnt(8)
    v_mfma_f32_32x32x16_bf16 v[128:143], v[228:231], v[48:51], v[128:143]
    s_waitcnt lgkmcnt(6)
    v_mfma_f32_32x32x16_bf16 v[112:127], v[208:211], v[52:55], v[112:127]
    ds_read_b64_tr_b16 v[224:225], v248 offset:30720
    ds_read_b64_tr_b16 v[226:227], v248 offset:31232
    ds_read_b64_tr_b16 v[228:229], v249 offset:30720
    ds_read_b64_tr_b16 v[230:231], v249 offset:31232
    s_waitcnt lgkmcnt(8)
    v_mfma_f32_32x32x16_bf16 v[128:143], v[212:215], v[52:55], v[128:143]
    s_waitcnt lgkmcnt(6)
    v_mfma_f32_32x32x16_bf16 v[112:127], v[216:219], v[56:59], v[112:127]
    ds_read_b64_tr_b16 v[208:209], v248 offset:32768
    ds_read_b64_tr_b16 v[210:211], v248 offset:33280
    ds_read_b64_tr_b16 v[212:213], v249 offset:32768
    ds_read_b64_tr_b16 v[214:215], v249 offset:33280
    s_waitcnt lgkmcnt(8)
    v_mfma_f32_32x32x16_bf16 v[128:143], v[220:223], v[56:59], v[128:143]
    s_waitcnt lgkmcnt(6)
    v_mfma_f32_32x32x16_bf16 v[112:127], v[224:227], v[60:63], v[112:127]
    ds_read_b64_tr_b16 v[216:217], v248 offset:34816
    ds_read_b64_tr_b16 v[218:219], v248 offset:35328
    ds_read_b64_tr_b16 v[220:221], v249 offset:34816
    ds_read_b64_tr_b16 v[222:223], v249 offset:35328
    s_waitcnt lgkmcnt(8)
    v_mfma_f32_32x32x16_bf16 v[128:143], v[228:231], v[60:63], v[128:143]
    s_waitcnt lgkmcnt(6)
    v_mfma_f32_32x32x16_bf16 v[112:127], v[208:211], v[64:67], v[112:127]
    ds_read_b64_tr_b16 v[224:225], v248 offset:36864
    ds_read_b64_tr_b16 v[226:227], v248 offset:37376
    ds_read_b64_tr_b16 v[228:229], v249 offset:36864
    ds_read_b64_tr_b16 v[230:231], v249 offset:37376
    ds_read_b128 v[244:247], v255 offset:320
    s_waitcnt lgkmcnt(9)
    v_mfma_f32_32x32x16_bf16 v[128:143], v[212:215], v[64:67], v[128:143]
    s_waitcnt lgkmcnt(7)
    v_mfma_f32_32x32x16_bf16 v[112:127], v[216:219], v[68:71], v[112:127]
    ds_read_b64_tr_b16 v[208:209], v248 offset:38912
    ds_read_b64_tr_b16 v[210:211], v248 offset:39424
    ds_read_b64_tr_b16 v[212:213], v249 offset:38912
    ds_read_b64_tr_b16 v[214:215], v249 offset:39424
    s_waitcnt lgkmcnt(9)
    v_mfma_f32_32x32x16_bf16 v[128:143], v[220:223], v[68:71], v[128:143]
    s_waitcnt lgkmcnt(7)
    v_mfma_f32_32x32x16_bf16 v[112:127], v[224:227], v[72:75], v[112:127]
    s_waitcnt lgkmcnt(4)
    v_or3_b32 v244, v244, v245, v246
    v_or_b32 v244, v244, v247
    v_cmp_ne_u32 vcc, 0, v244
    s_nop 4
    s_cbranch_vccnz SLOW_105
RET_106:
    ds_read_b64_tr_b16 v[216:217], v248 offset:40960
    ds_read_b64_tr_b16 v[218:219], v248 offset:41472
    ds_read_b64_tr_b16 v[220:221], v249 offset:40960
    ds_read_b64_tr_b16 v[222:223], v249 offset:41472
    v_mfma_f32_32x32x16_bf16 v[128:143], v[228:231], v[72:75], v[128:143]
    s_waitcnt lgkmcnt(6)
    v_mfma_f32_32x32x16_bf16 v[112:127], v[208:211], v[76:79], v[112:127]
    ds_read_b64_tr_b16 v[224:225], v248 offset:43008
    ds_read_b64_tr_b16 v[226:227], v248 offset:43520
    ds_read_b64_tr_b16 v[228:229], v249 offset:43008
    ds_read_b64_tr_b16 v[230:231], v249 offset:43520
    s_waitcnt lgkmcnt(8)
    v_mfma_f32_32x32x16_bf16 v[128:143], v[212:215], v[76:79], v[128:143]
    s_waitcnt lgkmcnt(6)
    v_mfma_f32_32x32x16_bf16 v[112:127], v[216:219], v[80:83], v[112:127]
    ds_read_b64_tr_b16 v[208:209], v248 offset:45056
    ds_read_b64_tr_b16 v[210:211], v248 offset:45568
    ds_read_b64_tr_b16 v[212:213], v249 offset:45056
    ds_read_b64_tr_b16 v[214:215], v249 offset:45568
    s_waitcnt lgkmcnt(8)
    v_mfma_f32_32x32x16_bf16 v[128:143], v[220:223], v[80:83], v[128:143]
    s_waitcnt lgkmcnt(6)
    v_mfma_f32_32x32x16_bf16 v[112:127], v[224:227], v[84:87], v[112:127]
    ds_read_b64_tr_b16 v[216:217], v248 offset:47104
    ds_read_b64_tr_b16 v[218:219], v248 offset:47616
    ds_read_b64_tr_b16 v[220:221], v249 offset:47104
    ds_read_b64_tr_b16 v[222:223], v249 offset:47616
    s_waitcnt lgkmcnt(8)
    v_mfma_f32_32x32x16_bf16 v[128:143], v[228:231], v[84:87], v[128:143]
    s_waitcnt lgkmcnt(6)
    v_mfma_f32_32x32x16_bf16 v[112:127], v[208:211], v[88:91], v[112:127]
    ds_read_b64_tr_b16 v[224:225], v248 offset:49152
    ds_read_b64_tr_b16 v[226:227], v248 offset:49664
    ds_read_b64_tr_b16 v[228:229], v249 offset:49152
    ds_read_b64_tr_b16 v[230:231], v249 offset:49664
    s_waitcnt lgkmcnt(8)
    v_mfma_f32_32x32x16_bf16 v[128:143], v[212:215], v[88:91], v[128:143]
    s_waitcnt vmcnt(0)
    v_mov_b32 v232, s60
    v_mov_b32 v233, s61
    v_lshlrev_b32 v234, 3, v240
    s_mov_b64 exec, 0xffff
    buffer_store_dwordx2 v[232:233], v234, s[16:19], s41 offen sc1
    s_mov_b64 exec, -1
    s_waitcnt lgkmcnt(6)
    v_mfma_f32_32x32x16_bf16 v[112:127], v[216:219], v[92:95], v[112:127]
    ds_read_b64_tr_b16 v[208:209], v248 offset:51200
    ds_read_b64_tr_b16 v[210:211], v248 offset:51712
    ds_read_b64_tr_b16 v[212:213], v249 offset:51200
    ds_read_b64_tr_b16 v[214:215], v249 offset:51712
    s_waitcnt lgkmcnt(8)
    v_mfma_f32_32x32x16_bf16 v[128:143], v[220:223], v[92:95], v[128:143]
    s_waitcnt lgkmcnt(6)
    v_mfma_f32_32x32x16_bf16 v[112:127], v[224:227], v[96:99], v[112:127]
    ds_read_b64_tr_b16 v[216:217], v248 offset:53248
    ds_read_b64_tr_b16 v[218:219], v248 offset:53760
    ds_read_b64_tr_b16 v[220:221], v249 offset:53248
    ds_read_b64_tr_b16 v[222:223], v249 offset:53760
    ds_read_b128 v[244:247], v255 offset:672
    s_waitcnt lgkmcnt(9)
    v_mfma_f32_32x32x16_bf16 v[128:143], v[228:231], v[96:99], v[128:143]
    s_waitcnt lgkmcnt(7)
    v_mfma_f32_32x32x16_bf16 v[112:127], v[208:211], v[100:103], v[112:127]
    ds_read_b64_tr_b16 v[224:225], v248 offset:55296
    ds_read_b64_tr_b16 v[226:227], v248 offset:55808
    ds_read_b64_tr_b16 v[228:229], v249 offset:55296
    ds_read_b64_tr_b16 v[230:231], v249 offset:55808
    s_waitcnt lgkmcnt(9)
    v_mfma_f32_32x32x16_bf16 v[128:143], v[212:215], v[100:103], v[128:143]
    s_waitcnt lgkmcnt(7)
    v_mfma_f32_32x32x16_bf16 v[112:127], v[216:219], v[104:107], v[112:127]
    s_waitcnt lgkmcnt(4)
    v_or3_b32 v244, v244, v245, v246
    v_or_b32 v244, v244, v247
    v_cmp_ne_u32 vcc, 0, v244
    s_nop 4
    s_cbranch_vccnz SLOW_107
RET_108:
    ds_read_b128 v[208:211], v253 offset:0
    ds_read_b128 v[212:215], v253 offset:1024
    v_mfma_f32_32x32x16_bf16 v[128:143], v[220:223], v[104:107], v[128:143]
    s_waitcnt lgkmcnt(4)
    v_mfma_f32_32x32x16_bf16 v[112:127], v[224:227], v[108:111], v[112:127]
    s_waitcnt lgkmcnt(2)
    v_mfma_f32_32x32x16_bf16 v[128:143], v[228:231], v[108:111], v[128:143]
    s_waitcnt lgkmcnt(1)
    v_mfma_f32_32x32x16_bf16 v[112:127], v[208:211], v[236:239], v[112:127]
    s_waitcnt lgkmcnt(0)
    v_mfma_f32_32x32x16_bf16 v[128:143], v[212:215], v[236:239], v[128:143]
    s_add_u32 m0, s46, 592
    s_mov_b64 exec, 1
    buffer_load_dword v255, s[36:39], 0 offen lds
    s_mov_b64 exec, -1
    s_mov_b32 s56, 48
    s_lshl_b32 s54, s56, 12
    s_add_u32 s54, s54, s100
    s_lshl_b32 s48, s56, 7
    s_add_u32 s48, s48, s101
    s_cmp_ge_u32 s56, 21
    s_cselect_b32 s57, 0, 0xff7fffff
    s_cselect_b32 s58, 1.0, 0
    s_cselect_b32 s59, 0, 1.0
    s_cmp_lt_u32 s56, 7
    s_cselect_b32 s59, 0x3e8b97f6, s59
    s_mov_b32 s47, s54
    s_setprio 2
    s_and_b32 s50, s2, 7
    s_lshl_b32 s50, s50, 1
    s_and_b32 s51, s42, 1
    s_add_u32 s50, s50, s51
    s_lshr_b32 s51, s42, 1
    s_mul_i32 s53, s50, 7
    s_lshr_b32 s53, s53, 1
    s_lshl_b32 s54, s51, 2
    s_add_u32 s52, s54, s40
    s_mul_i32 s55, s40, 3
    s_add_u32 s54, s54, s55
    s_sub_u32 s54, s54, 8
    v_and_b32 v216, 1, v240
    v_mul_u32_u24 v217, 3, v216
    v_add_u32 v217, s53, v217
    v_lshrrev_b32 v217, 3, v217
    v_bfe_u32 v218, v240, 1, 2
    v_add_u32 v219, s54, v218
    v_mov_b32 v220, s52
    v_cmp_eq_u32 vcc, 3, v218
    v_add_u32 v221, 7, v217
    v_mov_b32 v226, 0
    v_cndmask_b32 v219, v219, v220, vcc
    v_cndmask_b32 v221, v221, v217, vcc
    v_cmp_gt_i32 vcc, 0, v219
    v_add_u32 v217, 14, v217
    v_mov_b32 v227, 0
    v_cndmask_b32 v219, v219, v220, vcc
    v_cmp_lt_u32 vcc, 7, v240
    v_lshlrev_b32 v224, 13, v219
    v_add_u32 v224, 14942208, v224
    v_cndmask_b32 v221, v221, v217, vcc
    v_lshl_add_u32 v224, v221, 7, v224
    s_mov_b32 s100, 0xffff
    s_mov_b32 s101, 0
    s_and_b32 exec_lo, s100, 65535
    s_and_b32 exec_hi, s101, 0
    s_or_b32 exec_lo, exec_lo, 1
    buffer_load_dwordx2 v[226:227], v224, s[16:19], 0 offen sc1
    s_mov_b64 exec, -1
    v_mul_f32 v241, v235, v235
    v_mul_f32 v241, s58, v241
    v_mul_f32 v242, s59, v235
    v_max_f32 v112, s57, v112
    v_max_f32 v113, s57, v113
    v_fma_f32 v243, v112, v241, v242
    v_fma_f32 v254, v113, v241, v242
    v_mul_f32 v243, v112, v243
    v_mul_f32 v254, v113, v254
    v_cvt_pk_bf16_f32 v96, v243, v254
    v_max_f32 v114, s57, v114
    v_max_f32 v115, s57, v115
    v_fma_f32 v243, v114, v241, v242
    v_fma_f32 v254, v115, v241, v242
    v_mul_f32 v243, v114, v243
    v_mul_f32 v254, v115, v254
    v_cvt_pk_bf16_f32 v97, v243, v254
    v_max_f32 v116, s57, v116
    v_max_f32 v117, s57, v117
    v_fma_f32 v243, v116, v241, v242
    v_fma_f32 v254, v117, v241, v242
    v_mul_f32 v243, v116, v243
    v_mul_f32 v254, v117, v254
    v_cvt_pk_bf16_f32 v98, v243, v254
    v_max_f32 v118, s57, v118
    v_max_f32 v119, s57, v119
    v_fma_f32 v243, v118, v241, v242
    v_fma_f32 v254, v119, v241, v242
    v_mul_f32 v243, v118, v243
    v_mul_f32 v254, v119, v254
    v_cvt_pk_bf16_f32 v99, v243, v254
    v_max_f32 v120, s57, v120
    v_max_f32 v121, s57, v121
    v_fma_f32 v243, v120, v241, v242
    v_fma_f32 v254, v121, v241, v242
    v_mul_f32 v243, v120, v243
    v_mul_f32 v254, v121, v254
    v_cvt_pk_bf16_f32 v100, v243, v254
    v_max_f32 v122, s57, v122
    v_max_f32 v123, s57, v123
    v_fma_f32 v243, v122, v241, v242
    v_fma_f32 v254, v123, v241, v242
    v_mul_f32 v243, v122, v243
    v_mul_f32 v254, v123, v254
    v_cvt_pk_bf16_f32 v101, v243, v254
    v_max_f32 v124, s57, v124
    v_max_f32 v125, s57, v125
    v_fma_f32 v243, v124, v241, v242
    v_fma_f32 v254, v125, v241, v242
    v_mul_f32 v243, v124, v243
    v_mul_f32 v254, v125, v254
    v_cvt_pk_bf16_f32 v102, v243, v254
    v_max_f32 v126, s57, v126
    v_max_f32 v127, s57, v127
    v_fma_f32 v243, v126, v241, v242
    v_fma_f32 v254, v127, v241, v242
    v_mul_f32 v243, v126, v243
    v_mul_f32 v254, v127, v254
    v_cvt_pk_bf16_f32 v103, v243, v254
    v_max_f32 v128, s57, v128
    v_max_f32 v129, s57, v129
    v_fma_f32 v243, v128, v241, v242
    v_fma_f32 v254, v129, v241, v242
    v_mul_f32 v243, v128, v243
    v_mul_f32 v254, v129, v254
    v_cvt_pk_bf16_f32 v104, v243, v254
    v_max_f32 v130, s57, v130
    v_max_f32 v131, s57, v131
    v_fma_f32 v243, v130, v241, v242
    v_fma_f32 v254, v131, v241, v242
    v_mul_f32 v243, v130, v243
    v_mul_f32 v254, v131, v254
    v_cvt_pk_bf16_f32 v105, v243, v254
    v_max_f32 v132, s57, v132
    v_max_f32 v133, s57, v133
    v_fma_f32 v243, v132, v241, v242
    v_fma_f32 v254, v133, v241, v242
    v_mul_f32 v243, v132, v243
    v_mul_f32 v254, v133, v254
    v_cvt_pk_bf16_f32 v106, v243, v254
    v_max_f32 v134, s57, v134
    v_max_f32 v135, s57, v135
    v_fma_f32 v243, v134, v241, v242
    v_fma_f32 v254, v135, v241, v242
    v_mul_f32 v243, v134, v243
    v_mul_f32 v254, v135, v254
    v_cvt_pk_bf16_f32 v107, v243, v254
    v_max_f32 v136, s57, v136
    v_max_f32 v137, s57, v137
    v_fma_f32 v243, v136, v241, v242
    v_fma_f32 v254, v137, v241, v242
    v_mul_f32 v243, v136, v243
    v_mul_f32 v254, v137, v254
    v_cvt_pk_bf16_f32 v108, v243, v254
    v_max_f32 v138, s57, v138
    v_max_f32 v139, s57, v139
    v_fma_f32 v243, v138, v241, v242
    v_fma_f32 v254, v139, v241, v242
    v_mul_f32 v243, v138, v243
    v_mul_f32 v254, v139, v254
    v_cvt_pk_bf16_f32 v109, v243, v254
    v_max_f32 v140, s57, v140
    v_max_f32 v141, s57, v141
    v_fma_f32 v243, v140, v241, v242
    v_fma_f32 v254, v141, v241, v242
    v_mul_f32 v243, v140, v243
    v_mul_f32 v254, v141, v254
    v_cvt_pk_bf16_f32 v110, v243, v254
    v_max_f32 v142, s57, v142
    v_max_f32 v143, s57, v143
    v_fma_f32 v243, v142, v241, v242
    v_fma_f32 v254, v143, v241, v242
    v_mul_f32 v243, v142, v243
    v_mul_f32 v254, v143, v254
    v_cvt_pk_bf16_f32 v111, v243, v254
    s_mov_b32 s48, s48
    s_branch G_attn
SLOW_57:
    s_mov_b32 s63, 0
    s_waitcnt lgkmcnt(0)
ZS_109:
    ds_read_b128 v[244:247], v255 offset:16
    s_add_u32 s63, s63, 1
    s_cmp_lt_u32 s63, 131072
    s_waitcnt lgkmcnt(0)
    v_or3_b32 v244, v244, v245, v246
    v_or_b32 v244, v244, v247
    v_cmp_ne_u32 vcc, 0, v244
    s_cbranch_scc0 ZD_110
    s_nop 3
    s_cbranch_vccnz ZS_109
ZD_110:
    s_branch RET_58
SLOW_59:
    s_mov_b32 s63, 0
    s_waitcnt lgkmcnt(0)
ZS_111:
    ds_read_b128 v[244:247], v255 offset:32
    s_add_u32 s63, s63, 1
    s_cmp_lt_u32 s63, 131072
    s_waitcnt lgkmcnt(0)
    v_or3_b32 v244, v244, v245, v246
    v_or_b32 v244, v244, v247
    v_cmp_ne_u32 vcc, 0, v244
    s_cbranch_scc0 ZD_112
    s_nop 3
    s_cbranch_vccnz ZS_111
ZD_112:
    s_branch RET_60
SLOW_61:
    s_mov_b32 s63, 0
    s_waitcnt lgkmcnt(0)
ZS_113:
    ds_read_b128 v[244:247], v255 offset:48
    s_add_u32 s63, s63, 1
    s_cmp_lt_u32 s63, 131072
    s_waitcnt lgkmcnt(0)
    v_or3_b32 v244, v244, v245, v246
    v_or_b32 v244, v244, v247
    v_cmp_ne_u32 vcc, 0, v244
    s_cbranch_scc0 ZD_114
    s_nop 3
    s_cbranch_vccnz ZS_113
ZD_114:
    s_branch RET_62
SLOW_63:
    s_mov_b32 s63, 0
    s_waitcnt lgkmcnt(0)
ZS_115:
    ds_read_b128 v[244:247], v255 offset:64
    s_add_u32 s63, s63, 1
    s_cmp_lt_u32 s63, 131072
    s_waitcnt lgkmcnt(0)
    v_or3_b32 v244, v244, v245, v246
    v_or_b32 v244, v244, v247
    v_cmp_ne_u32 vcc, 0, v244
    s_cbranch_scc0 ZD_116
    s_nop 3
    s_cbranch_vccnz ZS_115
ZD_116:
    s_branch RET_64
SLOW_65:
    s_mov_b32 s63, 0
    s_waitcnt lgkmcnt(0)
ZS_117:
    ds_read_b128 v[244:247], v255 offset:80
    s_add_u32 s63, s63, 1
    s_cmp_lt_u32 s63, 131072
    s_waitcnt lgkmcnt(0)
    v_or3_b32 v244, v244, v245, v246
    v_or_b32 v244, v244, v247
    v_cmp_ne_u32 vcc, 0, v244
    s_cbranch_scc0 ZD_118
    s_nop 3
    s_cbranch_vccnz ZS_117
ZD_118:
    s_branch RET_66
SLOW_67:
    s_mov_b32 s63, 0
    s_waitcnt lgkmcnt(0)
ZS_119:
    ds_read_b128 v[244:247], v255 offset:96
    s_add_u32 s63, s63, 1
    s_cmp_lt_u32 s63, 131072
    s_waitcnt lgkmcnt(0)
    v_or3_b32 v244, v244, v245, v246
    v_or_b32 v244, v244, v247
    v_cmp_ne_u32 vcc, 0, v244
    s_cbranch_scc0 ZD_120
    s_nop 3
    s_cbranch_vccnz ZS_119
ZD_120:
    s_branch RET_68
SLOW_69:
    s_mov_b32 s63, 0
    s_waitcnt lgkmcnt(0)
ZS_121:
    ds_read_b128 v[244:247], v255 offset:624
    s_add_u32 s63, s63, 1
    s_cmp_lt_u32 s63, 131072
    s_waitcnt lgkmcnt(0)
    v_or3_b32 v244, v244, v245, v246
    v_or_b32 v244, v244, v247
    v_cmp_ne_u32 vcc, 0, v244
    s_cbranch_scc0 ZD_122
    s_nop 3
    s_cbranch_vccnz ZS_121
ZD_122:
    s_branch RET_70
SLOW_71:
    s_mov_b32 s63, 0
    s_waitcnt lgkmcnt(0)
ZS_123:
    ds_read_b128 v[244:247], v255 offset:640
    s_add_u32 s63, s63, 1
    s_cmp_lt_u32 s63, 131072
    s_waitcnt lgkmcnt(0)
    v_or3_b32 v244, v244, v245, v246
    v_or_b32 v244, v244, v247
    v_cmp_ne_u32 vcc, 0, v244
    s_cbranch_scc0 ZD_124
    s_nop 3
    s_cbranch_vccnz ZS_123
ZD_124:
    s_branch RET_72
SLOW_73:
    s_mov_b32 s63, 0
ZS_125:
    ds_read_b128 v[244:247], v255 offset:112
    s_add_u32 s63, s63, 1
    s_cmp_lt_u32 s63, 131072
    s_waitcnt lgkmcnt(0)
    v_or3_b32 v244, v244, v245, v246
    v_or_b32 v244, v244, v247
    v_cmp_ne_u32 vcc, 0, v244
    s_cbranch_scc0 ZD_126
    s_nop 3
    s_cbranch_vccnz ZS_125
ZD_126:
    s_branch RET_74
SLOW_75:
    s_mov_b32 s63, 0
    s_waitcnt lgkmcnt(0)
ZS_127:
    ds_read_b128 v[244:247], v255 offset:128
    s_add_u32 s63, s63, 1
    s_cmp_lt_u32 s63, 131072
    s_waitcnt lgkmcnt(0)
    v_or3_b32 v244, v244, v245, v246
    v_or_b32 v244, v244, v247
    v_cmp_ne_u32 vcc, 0, v244
    s_cbranch_scc0 ZD_128
    s_nop 3
    s_cbranch_vccnz ZS_127
ZD_128:
    s_branch RET_76
SLOW_77:
    s_mov_b32 s63, 0
NON_129:
    buffer_load_dwordx2 v[232:233], v234, s[36:39], 0 offen sc1
    s_waitcnt vmcnt(0)
    v_readfirstlane_b32 s60, v232
    v_readfirstlane_b32 s61, v233
    s_add_u32 s63, s63, 1
    s_cmp_gt_u32 s63, 0x8000
    s_cbranch_scc1 NOND_130
    s_cmp_lg_u32 s60, 0
    s_cbranch_scc1 NOND_130
    s_sleep 8
    s_branch NON_129
NOND_130:
    s_branch RET_78
SLOW_79:
    s_mov_b32 s63, 0
    s_waitcnt lgkmcnt(0)
ZS_131:
    ds_read_b128 v[244:247], v255 offset:160
    s_add_u32 s63, s63, 1
    s_cmp_lt_u32 s63, 131072
    s_waitcnt lgkmcnt(0)
    v_or3_b32 v244, v244, v245, v246
    v_or_b32 v244, v244, v247
    v_cmp_ne_u32 vcc, 0, v244
    s_cbranch_scc0 ZD_132
    s_nop 3
    s_cbranch_vccnz ZS_131
ZD_132:
    s_branch RET_80
SLOW_81:
    s_mov_b32 s63, 0
    s_waitcnt lgkmcnt(0)
ZS_133:
    ds_read_b128 v[244:247], v255 offset:192
    s_add_u32 s63, s63, 1
    s_cmp_lt_u32 s63, 131072
    s_waitcnt lgkmcnt(0)
    v_or3_b32 v244, v244, v245, v246
    v_or_b32 v244, v244, v247
    v_cmp_ne_u32 vcc, 0, v244
    s_cbranch_scc0 ZD_134
    s_nop 3
    s_cbranch_vccnz ZS_133
ZD_134:
    s_branch RET_82
SLOW_83:
    s_mov_b32 s63, 0
    s_waitcnt lgkmcnt(0)
ZS_135:
    ds_read_b128 v[244:247], v255 offset:208
    s_add_u32 s63, s63, 1
    s_cmp_lt_u32 s63, 131072
    s_waitcnt lgkmcnt(0)
    v_or3_b32 v244, v244, v245, v246
    v_or_b32 v244, v244, v247
    v_cmp_ne_u32 vcc, 0, v244
    s_cbranch_scc0 ZD_136
    s_nop 3
    s_cbranch_vccnz ZS_135
ZD_136:
    s_branch RET_84
SLOW_85:
    s_mov_b32 s63, 0
    s_waitcnt lgkmcnt(0)
ZS_137:
    ds_read_b128 v[244:247], v255 offset:656
    s_add_u32 s63, s63, 1
    s_cmp_lt_u32 s63, 131072
    s_waitcnt lgkmcnt(0)
    v_or3_b32 v244, v244, v245, v246
    v_or_b32 v244, v244, v247
    v_cmp_ne_u32 vcc, 0, v244
    s_cbranch_scc0 ZD_138
    s_nop 3
    s_cbranch_vccnz ZS_137
ZD_138:
    s_branch RET_86
SLOW_87:
    s_mov_b32 s63, 0
ZS_139:
    ds_read_b128 v[244:247], v255 offset:576
    s_add_u32 s63, s63, 1
    s_cmp_lt_u32 s63, 131072
    s_waitcnt lgkmcnt(0)
    v_or3_b32 v244, v244, v245, v246
    v_or_b32 v244, v244, v247
    v_cmp_ne_u32 vcc, 0, v244
    s_cbranch_scc0 ZD_140
    s_nop 3
    s_cbranch_vccnz ZS_139
ZD_140:
    s_branch RET_88
SLOW_89:
    s_mov_b32 s63, 0
POLL_141:
    s_and_b32 exec_lo, s100, 65535
    s_and_b32 exec_hi, s101, 0
    s_or_b32 exec_lo, exec_lo, 1
    buffer_load_dwordx2 v[226:227], v224, s[16:19], 0 offen sc1
    s_mov_b64 exec, -1
    s_waitcnt vmcnt(0)
    v_cmp_ne_u64 vcc, s[60:61], v[226:227]
    s_nop 0
    s_and_b64 s[100:101], s[100:101], vcc
    s_and_b32 s62, s100, 255
    s_cbranch_scc0 POLLD_142
    s_sleep 8
    s_add_u32 s63, s63, 1
    s_cmp_lt_u32 s63, 0x8000
    s_cbranch_scc1 POLL_141
POLLD_142:
    s_branch RET_90
SLOW_91:
    s_mov_b32 s63, 0
POLL_143:
    s_and_b32 exec_lo, s100, 65280
    s_and_b32 exec_hi, s101, 0
    s_or_b32 exec_lo, exec_lo, 256
    buffer_load_dwordx2 v[226:227], v224, s[16:19], 0 offen sc1
    s_mov_b64 exec, -1
    s_waitcnt vmcnt(0)
    v_cmp_ne_u64 vcc, s[60:61], v[226:227]
    s_nop 0
    s_and_b64 s[100:101], s[100:101], vcc
    s_and_b32 s62, s100, 65280
    s_cbranch_scc0 POLLD_144
    s_sleep 8
    s_add_u32 s63, s63, 1
    s_cmp_lt_u32 s63, 0x8000
    s_cbranch_scc1 POLL_143
POLLD_144:
    s_branch RET_92
SLOW_95:
    v_mov_b32 v0, 0xf149f2ca
    v_mov_b32 v1, 0xf149f2ca
    v_mov_b32 v2, 0xf149f2ca
    v_mov_b32 v3, 0xf149f2ca
    v_mov_b32 v4, 0xf149f2ca
    v_mov_b32 v5, 0xf149f2ca
    v_mov_b32 v6, 0xf149f2ca
    v_mov_b32 v7, 0xf149f2ca
    v_mov_b32 v8, 0xf149f2ca
    v_mov_b32 v9, 0xf149f2ca
    v_mov_b32 v10, 0xf149f2ca
    v_mov_b32 v11, 0xf149f2ca
    v_mov_b32 v12, 0xf149f2ca
    v_mov_b32 v13, 0xf149f2ca
    v_mov_b32 v14, 0xf149f2ca
    v_mov_b32 v15, 0xf149f2ca
    s_branch RET_96
SLOW_97:
    s_mov_b32 s63, 0
ZS_145:
    ds_read_b128 v[244:247], v255 offset:704
    s_add_u32 s63, s63, 1
    s_cmp_lt_u32 s63, 131072
    s_waitcnt lgkmcnt(0)
    v_or3_b32 v244, v244, v245, v246
    v_or_b32 v244, v244, v247
    v_cmp_ne_u32 vcc, 0, v244
    s_cbranch_scc0 ZD_146
    s_nop 3
    s_cbranch_vccnz ZS_145
ZD_146:
    s_branch RET_98
SLOW_101:
    s_mov_b32 s63, 0
    s_waitcnt lgkmcnt(0)
ZS_147:
    ds_read_b128 v[244:247], v255 offset:256
    s_add_u32 s63, s63, 1
    s_cmp_lt_u32 s63, 131072
    s_waitcnt lgkmcnt(0)
    v_or3_b32 v244, v244, v245, v246
    v_or_b32 v244, v244, v247
    v_cmp_ne_u32 vcc, 0, v244
    s_cbranch_scc0 ZD_148
    s_nop 3
    s_cbranch_vccnz ZS_147
ZD_148:
    s_branch RET_102
SLOW_103:
    s_mov_b32 s63, 0
    s_waitcnt lgkmcnt(0)
ZS_149:
    ds_read_b128 v[244:247], v255 offset:288
    s_add_u32 s63, s63, 1
    s_cmp_lt_u32 s63, 131072
    s_waitcnt lgkmcnt(0)
    v_or3_b32 v244, v244, v245, v246
    v_or_b32 v244, v244, v247
    v_cmp_ne_u32 vcc, 0, v244
    s_cbranch_scc0 ZD_150
    s_nop 3
    s_cbranch_vccnz ZS_149
ZD_150:
    s_branch RET_104
SLOW_105:
    s_mov_b32 s63, 0
    s_waitcnt lgkmcnt(0)
ZS_151:
    ds_read_b128 v[244:247], v255 offset:320
    s_add_u32 s63, s63, 1
    s_cmp_lt_u32 s63, 131072
    s_waitcnt lgkmcnt(0)
    v_or3_b32 v244, v244, v245, v246
    v_or_b32 v244, v244, v247
    v_cmp_ne_u32 vcc, 0, v244
    s_cbranch_scc0 ZD_152
    s_nop 3
    s_cbranch_vccnz ZS_151
ZD_152:
    s_branch RET_106
SLOW_107:
    s_mov_b32 s63, 0
    s_waitcnt lgkmcnt(0)
ZS_153:
    ds_read_b128 v[244:247], v255 offset:672
    s_add_u32 s63, s63, 1
    s_cmp_lt_u32 s63, 131072
    s_waitcnt lgkmcnt(0)
    v_or3_b32 v244, v244, v245, v246
    v_or_b32 v244, v244, v247
    v_cmp_ne_u32 vcc, 0, v244
    s_cbranch_scc0 ZD_154
    s_nop 3
    s_cbranch_vccnz ZS_153
ZD_154:
    s_branch RET_108
K_end:
    s_endpgm
.section .rodata,"a"
.p2align 6
.amdhsa_kernel parallel_sum__sliding_block__dense_activation_squared_relu__prompt_kernel
  .amdhsa_next_free_vgpr 256
  .amdhsa_next_free_sgpr 102
  .amdhsa_accum_offset 256
  .amdhsa_group_segment_fixed_size 0
  .amdhsa_kernarg_size 88
  .amdhsa_user_sgpr_count 2
  .amdhsa_user_sgpr_kernarg_segment_ptr 1
  .amdhsa_system_sgpr_workgroup_id_x 1
  .amdhsa_float_denorm_mode_32 3
.end_amdhsa_kernel
```
